```python
import torch

def _softmax(x, axis=-1):
    return torch.softmax(x, dim=axis)
def _gelu(x):
    return torch.nn.functional.gelu(x, approximate="tanh")
def _silu(x):
    return torch.nn.functional.silu(x)
def _sigmoid(x):
    return torch.sigmoid(x)
def _layernorm(x, axis=-1, eps=1e-5):
    m = x.mean(dim=axis, keepdim=True)
    v = x.var(dim=axis, keepdim=True, unbiased=False)
    return (x - m) / torch.sqrt(v + eps)
def _scatter_add(tgt, idx, src, axis=0):
    return tgt.clone().index_add_(axis, idx, src)
def _segment_sum(src, seg, n):
    out = torch.zeros((n,) + src.shape[1:], dtype=src.dtype)
    return out.index_add_(0, seg, src)
def _pad(x, pw):
    flat = tuple(v for pair in reversed(pw) for v in pair)
    return torch.nn.functional.pad(x, flat)

kernel_name = 'gated_mix__linear_kernel_hedgehog__mixer_token_mlp__prompt'

def setup_inputs():

    _w = (lambda a: (lambda t: t.to(torch.bfloat16) if t.is_floating_point() else t)(torch.as_tensor(a)))
    def _A_setup():
        B, S, D, H = 1, 2048, 512, 32
        Dh = D // H
        return {
            "x": _w((lambda *s: torch.randn(*s, dtype=torch.bfloat16) * 0.05)(B, S, D)),
            "wqkv": _w((lambda *s: torch.randn(*s, dtype=torch.bfloat16) * 0.8)(D, 3 * D)),
            "w_phi": _w((lambda *s: torch.randn(*s, dtype=torch.bfloat16) * 0.8)(H, Dh, Dh) * (Dh ** -0.5)),
            "wo": _w((lambda *s: torch.randn(*s, dtype=torch.bfloat16) * 0.05)(D, D)),
        }
    _A_in = _A_setup()

    def _B_setup():
        B, S, D, F = 1, 2048, 512, 1376
        return {
            "x": _w((lambda *s: torch.randn(*s, dtype=torch.bfloat16) * 0.05)(B, S, D)),
            "w1": _w((lambda *s: torch.randn(*s, dtype=torch.bfloat16) * 0.4)(S, F) * (S ** -0.5)),
            "b1": _w((lambda *s: torch.randn(*s, dtype=torch.bfloat16) * 3.2)(F) * 0.02),
            "w2": _w((lambda *s: torch.randn(*s, dtype=torch.bfloat16) * 0.1)(F, S) * (F ** -0.5)),
            "b2": _w((lambda *s: torch.randn(*s, dtype=torch.bfloat16) * 0.4)(S) * 0.02),
        }
    _B_in = _B_setup()

    return {
        "A_x": _A_in["x"],
        "A_wqkv": _A_in["wqkv"],
        "A_w_phi": _A_in["w_phi"],
        "A_wo": _A_in["wo"],
        "B_x": _B_in["x"],
        "B_w1": _B_in["w1"],
        "B_b1": _B_in["b1"],
        "B_w2": _B_in["w2"],
        "B_b2": _B_in["b2"],
        "gate_w": _w((lambda *s: torch.randn(*s, dtype=torch.bfloat16) * 0.05)(512) * 16.0),
    }

def reference(A_x, A_wqkv, A_w_phi, A_wo, B_x, B_w1, B_b1, B_w2, B_b2, gate_w):
    def _A_ref(x, wqkv, w_phi, wo):
        B, S, D = x.shape
        H = 32; Dh = D // H
        qkv = (lambda x, *d: x.permute(*d))((x @ wqkv).reshape(B, S, 3, H, Dh), 2, 0, 3, 1, 4)
        q, k, v = qkv[0], qkv[1], qkv[2]
        pq = torch.einsum("bhsd,hdf->bhsf", q, w_phi)
        pk = torch.einsum("bhsd,hdf->bhsf", k, w_phi)
        phi_q = torch.concatenate([_softmax(pq, axis=-1), _softmax(-pq, axis=-1)], axis=-1)
        phi_k = torch.concatenate([_softmax(pk, axis=-1), _softmax(-pk, axis=-1)], axis=-1)
        kv = torch.einsum("bhsf,bhsd->bhfd", phi_k, v)
        z  = torch.einsum("bhsf->bhf", phi_k)
        num = torch.einsum("bhqf,bhfd->bhqd", phi_q, kv)
        den = torch.einsum("bhqf,bhf->bhq", phi_q, z)[..., None] + 1e-6
        o = num / den
        return (lambda x, *d: x.permute(*d))(o, 0, 2, 1, 3).reshape(B, S, D) @ wo

    def _B_ref(x, w1, b1, w2, b2):
        B, S, D = x.shape
        h = _layernorm(x, axis=-1)
        u = torch.einsum("bsd,sf->bdf", h, w1) + b1
        u = _gelu(u)
        y = torch.einsum("bdf,fs->bds", u, w2) + b2
        return (lambda x, *d: x.permute(*d))(y, 0, 2, 1)

    x = A_x
    g = _sigmoid((x * gate_w).sum(-1, keepdims=True))
    a = _A_ref(x, A_wqkv, A_w_phi, A_wo)
    b = _B_ref(x, B_w1, B_b1, B_w2, B_b2)
    return g * a + (1 - g) * b
```

```asm
; @launch grid=(256,1,1) block=(512,1,1) lds=159936
.amdgcn_target "amdgcn-amd-amdhsa--gfx950"
.text
.globl gated_mix__linear_kernel_hedgehog__mixer_token_mlp__prompt_kernel
.p2align 8
.type gated_mix__linear_kernel_hedgehog__mixer_token_mlp__prompt_kernel,@function
gated_mix__linear_kernel_hedgehog__mixer_token_mlp__prompt_kernel:
s_cmp_ge_u32 s2, 256
s_cbranch_scc1 gated_mix__linear_kernel_hedgehog__mixer_token_mlp__prompt_kernel_end
s_getpc_b64 s[4:5]
gated_mix__linear_kernel_hedgehog__mixer_token_mlp__prompt_kernel_pc:
s_lshr_b32 s6, s2, 3
s_mul_i32 s6, s6, 1152
v_and_b32 v1, 15, v0
v_lshlrev_b32 v1, 7, v1
v_add_u32 v1, s6, v1
v_min_u32 v1, gated_mix__linear_kernel_hedgehog__mixer_token_mlp__prompt_kernel_end-gated_mix__linear_kernel_hedgehog__mixer_token_mlp__prompt_kernel_pc, v1
v_mov_b32 v3, s5
v_add_co_u32 v2, vcc, s4, v1
s_nop 1
v_addc_co_u32 v3, vcc, 0, v3, vcc
v_cmp_gt_u32 vcc, 9, v0
s_and_saveexec_b64 s[6:7], vcc
s_cbranch_execz gated_mix__linear_kernel_hedgehog__mixer_token_mlp__prompt_kernel_nocpf
global_load_dword v230, v[2:3], off
gated_mix__linear_kernel_hedgehog__mixer_token_mlp__prompt_kernel_nocpf:
s_mov_b64 exec, s[6:7]
s_load_dwordx4 s[80:83], s[0:1], 88
s_load_dwordx4 s[60:63], s[0:1], 0
s_load_dwordx4 s[64:67], s[0:1], 16
s_load_dwordx4 s[68:71], s[0:1], 40
s_load_dwordx4 s[72:75], s[0:1], 56
s_load_dwordx4 s[76:79], s[0:1], 72
v_lshrrev_b32 v1, 6, v0
v_and_b32 v0, 63, v0
s_and_b32 s6, s2, 7
v_readfirstlane_b32 s8, v1
s_lshr_b32 s7, s2, 3
s_lshr_b32 s16, s6, 1
s_and_b32 s17, s6, 1
s_lshl_b32 s3, s16, 3
s_lshr_b32 s18, s7, 2
s_add_u32 s3, s3, s18
s_lshl_b32 s10, s3, 6
s_lshl_b32 s11, s17, 2
s_and_b32 s18, s7, 3
s_add_u32 s11, s11, s18
s_lshl_b32 s12, s6, 5
s_add_u32 s12, s12, s7
s_mul_i32 s18, s16, 22
s_add_u32 s18, s18, s7
s_lshr_b32 s21, s18, 2
s_and_b32 s18, s18, 3
s_lshl_b32 s22, s17, 2
s_add_u32 s22, s22, s18
s_mov_b32 s20, 0x3fb8aa3b
s_and_b32 s13, s8, 1
s_bfe_u32 s14, s8, 0x10001
s_and_b32 s15, s8, 3
s_lshl_b32 s100, s6, 2
s_lshr_b32 s18, s7, 3
s_add_u32 s100, s100, s18
s_waitcnt lgkmcnt(0)
s_and_b32 s81, s7, 7
s_lshl_b32 s80, s100, 6
s_mov_b32 s28, s82
s_mov_b32 s29, s83
s_mov_b32 s30, 0x2100000
s_mov_b32 s31, 0x20000
s_add_u32 s24, s82, 0x1800000
s_addc_u32 s25, s83, 0
s_cmp_ge_u32 s8, 4
s_cbranch_scc1 gated_mix__linear_kernel_hedgehog__mixer_token_mlp__prompt_kernel_C
s_load_dword s9, s[24:25], 0
s_mov_b32 s32, s60
s_mov_b32 s33, s61
s_mov_b32 s34, 0x200000
s_mov_b32 s35, 0x20000
s_mov_b32 s36, s62
s_mov_b32 s37, s63
s_mov_b32 s38, 0x180000
s_mov_b32 s39, 0x20000
v_lshlrev_b32 v5, 4, v0
s_cmp_ge_u32 s8, 2
s_cbranch_scc1 gated_mix__linear_kernel_hedgehog__mixer_token_mlp__prompt_kernel_LB
s_mov_b32 s40, s64
s_mov_b32 s41, s65
s_mov_b32 s42, 0x4000
s_mov_b32 s43, 0x20000
v_lshrrev_b32 v6, 3, v0
v_and_b32 v7, 7, v0
v_lshrrev_b32 v8, 4, v0
v_xor_b32 v9, v7, v8
v_lshlrev_b32 v9, 4, v9
v_lshl_add_u32 v2, v6, 10, v9
v_or_b32 v9, 4, v8
v_xor_b32 v9, v7, v9
v_lshlrev_b32 v9, 4, v9
v_lshl_add_u32 v3, v6, 10, v9
v_add_u32 v3, 8192, v3
v_and_b32 v8, 1, v8
v_lshlrev_b32 v8, 2, v8
v_xor_b32 v9, v7, v8
v_lshlrev_b32 v9, 4, v9
v_mul_u32_u24 v6, 3072, v6
v_add_u32 v4, v6, v9
s_barrier
s_lshl_b32 s16, s8, 10
s_add_u32 m0, s16, 131072
s_lshl_b32 s17, s11, 11
s_add_u32 s16, s16, s17
buffer_load_dwordx4 v5, s[40:43], s16 offen lds
s_lshl_b32 s18, s8, 5
s_add_u32 s16, s18, s10
s_lshl_b32 s16, s16, 10
s_mul_i32 s17, s18, 3072
s_lshl_b32 s18, s11, 7
s_add_u32 s17, s17, s18
s_lshl_b32 s19, s8, 12
s_add_u32 s44, s82, 0xf00000
s_addc_u32 s45, s83, 0
s_mov_b32 s46, 0x158000
s_mov_b32 s47, 0x20000
s_mov_b32 s48, s70
s_mov_b32 s49, s71
s_mov_b32 s50, 0xac0
s_mov_b32 s51, 0x20000
s_mov_b32 s52, s72
s_mov_b32 s53, s73
s_mov_b32 s54, 0x560000
s_mov_b32 s55, 0x20000
s_mov_b32 s56, s66
s_mov_b32 s57, s67
s_mov_b32 s58, 0x80000
s_mov_b32 s59, 0x20000
v_mov_b32 v14, 159920
s_mov_b32 s25, 0
sw_1:
ds_read_b32 v15, v14
s_add_u32 s25, s25, 1
s_waitcnt lgkmcnt(0)
v_readfirstlane_b32 s24, v15
s_cmp_ge_u32 s24, 2
s_cbranch_scc1 swd_2
s_cmp_lt_u32 s25, 4000000
s_cbranch_scc1 sw_1
swd_2:
s_add_u32 m0, s19, 0
s_add_u32 s18, s16, 0
buffer_load_dwordx4 v2, s[32:35], s18 offen lds
s_add_u32 m0, m0, 1024
s_nop 0
buffer_load_dwordx4 v3, s[32:35], s18 offen lds
s_add_u32 m0, s19, 2048
s_add_u32 s18, s16, 16384
buffer_load_dwordx4 v2, s[32:35], s18 offen lds
s_add_u32 m0, m0, 1024
s_nop 0
buffer_load_dwordx4 v3, s[32:35], s18 offen lds
s_add_u32 s16, s16, 128
s_add_u32 m0, s19, 8192
s_add_u32 s18, s17, 0
buffer_load_dwordx4 v4, s[36:39], s18 offen lds
s_add_u32 m0, s19, 9216
s_add_u32 s18, s17, 24576
buffer_load_dwordx4 v4, s[36:39], s18 offen lds
s_add_u32 m0, s19, 10240
s_add_u32 s18, s17, 49152
buffer_load_dwordx4 v4, s[36:39], s18 offen lds
s_add_u32 m0, s19, 11264
s_add_u32 s18, s17, 73728
buffer_load_dwordx4 v4, s[36:39], s18 offen lds
s_add_u32 m0, s19, 16384
s_add_u32 s18, s17, 1024
buffer_load_dwordx4 v4, s[36:39], s18 offen lds
s_add_u32 m0, s19, 17408
s_add_u32 s18, s17, 25600
buffer_load_dwordx4 v4, s[36:39], s18 offen lds
s_add_u32 m0, s19, 18432
s_add_u32 s18, s17, 50176
buffer_load_dwordx4 v4, s[36:39], s18 offen lds
s_add_u32 m0, s19, 19456
s_add_u32 s18, s17, 74752
buffer_load_dwordx4 v4, s[36:39], s18 offen lds
s_add_u32 m0, s19, 24576
s_add_u32 s18, s17, 2048
buffer_load_dwordx4 v4, s[36:39], s18 offen lds
s_add_u32 m0, s19, 25600
s_add_u32 s18, s17, 26624
buffer_load_dwordx4 v4, s[36:39], s18 offen lds
s_add_u32 m0, s19, 26624
s_add_u32 s18, s17, 51200
buffer_load_dwordx4 v4, s[36:39], s18 offen lds
s_add_u32 m0, s19, 27648
s_add_u32 s18, s17, 75776
buffer_load_dwordx4 v4, s[36:39], s18 offen lds
s_add_u32 s17, s17, 196608
s_add_u32 m0, s19, 32768
s_add_u32 s18, s16, 0
buffer_load_dwordx4 v2, s[32:35], s18 offen lds
s_add_u32 m0, m0, 1024
s_nop 0
buffer_load_dwordx4 v3, s[32:35], s18 offen lds
s_add_u32 m0, s19, 34816
s_add_u32 s18, s16, 16384
buffer_load_dwordx4 v2, s[32:35], s18 offen lds
s_add_u32 m0, m0, 1024
s_nop 0
buffer_load_dwordx4 v3, s[32:35], s18 offen lds
s_add_u32 s16, s16, 128
s_add_u32 m0, s19, 40960
s_add_u32 s18, s17, 0
buffer_load_dwordx4 v4, s[36:39], s18 offen lds
s_add_u32 m0, s19, 41984
s_add_u32 s18, s17, 24576
buffer_load_dwordx4 v4, s[36:39], s18 offen lds
s_add_u32 m0, s19, 43008
s_add_u32 s18, s17, 49152
buffer_load_dwordx4 v4, s[36:39], s18 offen lds
s_add_u32 m0, s19, 44032
s_add_u32 s18, s17, 73728
buffer_load_dwordx4 v4, s[36:39], s18 offen lds
s_add_u32 m0, s19, 49152
s_add_u32 s18, s17, 1024
buffer_load_dwordx4 v4, s[36:39], s18 offen lds
s_add_u32 m0, s19, 50176
s_add_u32 s18, s17, 25600
buffer_load_dwordx4 v4, s[36:39], s18 offen lds
s_add_u32 m0, s19, 51200
s_add_u32 s18, s17, 50176
buffer_load_dwordx4 v4, s[36:39], s18 offen lds
s_add_u32 m0, s19, 52224
s_add_u32 s18, s17, 74752
buffer_load_dwordx4 v4, s[36:39], s18 offen lds
s_add_u32 m0, s19, 57344
s_add_u32 s18, s17, 2048
buffer_load_dwordx4 v4, s[36:39], s18 offen lds
s_add_u32 m0, s19, 58368
s_add_u32 s18, s17, 26624
buffer_load_dwordx4 v4, s[36:39], s18 offen lds
s_add_u32 m0, s19, 59392
s_add_u32 s18, s17, 51200
buffer_load_dwordx4 v4, s[36:39], s18 offen lds
s_add_u32 m0, s19, 60416
s_add_u32 s18, s17, 75776
buffer_load_dwordx4 v4, s[36:39], s18 offen lds
s_add_u32 s17, s17, 196608
s_waitcnt vmcnt(16)
s_barrier
s_add_u32 m0, s19, 65536
s_add_u32 s18, s16, 0
buffer_load_dwordx4 v2, s[32:35], s18 offen lds
s_add_u32 m0, m0, 1024
s_nop 0
buffer_load_dwordx4 v3, s[32:35], s18 offen lds
s_add_u32 m0, s19, 67584
s_add_u32 s18, s16, 16384
buffer_load_dwordx4 v2, s[32:35], s18 offen lds
s_add_u32 m0, m0, 1024
s_nop 0
buffer_load_dwordx4 v3, s[32:35], s18 offen lds
s_add_u32 s16, s16, 128
s_add_u32 m0, s19, 73728
s_add_u32 s18, s17, 0
buffer_load_dwordx4 v4, s[36:39], s18 offen lds
s_add_u32 m0, s19, 74752
s_add_u32 s18, s17, 24576
buffer_load_dwordx4 v4, s[36:39], s18 offen lds
s_add_u32 m0, s19, 75776
s_add_u32 s18, s17, 49152
buffer_load_dwordx4 v4, s[36:39], s18 offen lds
s_add_u32 m0, s19, 76800
s_add_u32 s18, s17, 73728
buffer_load_dwordx4 v4, s[36:39], s18 offen lds
s_add_u32 m0, s19, 81920
s_add_u32 s18, s17, 1024
buffer_load_dwordx4 v4, s[36:39], s18 offen lds
s_add_u32 m0, s19, 82944
s_add_u32 s18, s17, 25600
buffer_load_dwordx4 v4, s[36:39], s18 offen lds
s_add_u32 m0, s19, 83968
s_add_u32 s18, s17, 50176
buffer_load_dwordx4 v4, s[36:39], s18 offen lds
s_add_u32 m0, s19, 84992
s_add_u32 s18, s17, 74752
buffer_load_dwordx4 v4, s[36:39], s18 offen lds
s_add_u32 m0, s19, 90112
s_add_u32 s18, s17, 2048
buffer_load_dwordx4 v4, s[36:39], s18 offen lds
s_add_u32 m0, s19, 91136
s_add_u32 s18, s17, 26624
buffer_load_dwordx4 v4, s[36:39], s18 offen lds
s_add_u32 m0, s19, 92160
s_add_u32 s18, s17, 51200
buffer_load_dwordx4 v4, s[36:39], s18 offen lds
s_add_u32 m0, s19, 93184
s_add_u32 s18, s17, 75776
buffer_load_dwordx4 v4, s[36:39], s18 offen lds
s_add_u32 s17, s17, 196608
s_waitcnt vmcnt(16)
s_barrier
s_add_u32 m0, s19, 98304
s_add_u32 s18, s16, 0
buffer_load_dwordx4 v2, s[32:35], s18 offen lds
s_add_u32 m0, m0, 1024
s_nop 0
buffer_load_dwordx4 v3, s[32:35], s18 offen lds
s_add_u32 m0, s19, 100352
s_add_u32 s18, s16, 16384
buffer_load_dwordx4 v2, s[32:35], s18 offen lds
s_add_u32 m0, m0, 1024
s_nop 0
buffer_load_dwordx4 v3, s[32:35], s18 offen lds
s_add_u32 s16, s16, 128
s_add_u32 m0, s19, 106496
s_add_u32 s18, s17, 0
buffer_load_dwordx4 v4, s[36:39], s18 offen lds
s_add_u32 m0, s19, 107520
s_add_u32 s18, s17, 24576
buffer_load_dwordx4 v4, s[36:39], s18 offen lds
s_add_u32 m0, s19, 108544
s_add_u32 s18, s17, 49152
buffer_load_dwordx4 v4, s[36:39], s18 offen lds
s_add_u32 m0, s19, 109568
s_add_u32 s18, s17, 73728
buffer_load_dwordx4 v4, s[36:39], s18 offen lds
s_add_u32 m0, s19, 114688
s_add_u32 s18, s17, 1024
buffer_load_dwordx4 v4, s[36:39], s18 offen lds
s_add_u32 m0, s19, 115712
s_add_u32 s18, s17, 25600
buffer_load_dwordx4 v4, s[36:39], s18 offen lds
s_add_u32 m0, s19, 116736
s_add_u32 s18, s17, 50176
buffer_load_dwordx4 v4, s[36:39], s18 offen lds
s_add_u32 m0, s19, 117760
s_add_u32 s18, s17, 74752
buffer_load_dwordx4 v4, s[36:39], s18 offen lds
s_add_u32 m0, s19, 122880
s_add_u32 s18, s17, 2048
buffer_load_dwordx4 v4, s[36:39], s18 offen lds
s_add_u32 m0, s19, 123904
s_add_u32 s18, s17, 26624
buffer_load_dwordx4 v4, s[36:39], s18 offen lds
s_add_u32 m0, s19, 124928
s_add_u32 s18, s17, 51200
buffer_load_dwordx4 v4, s[36:39], s18 offen lds
s_add_u32 m0, s19, 125952
s_add_u32 s18, s17, 75776
buffer_load_dwordx4 v4, s[36:39], s18 offen lds
s_add_u32 s17, s17, 196608
s_waitcnt vmcnt(16)
s_barrier
s_add_u32 m0, s19, 0
s_add_u32 s18, s16, 0
buffer_load_dwordx4 v2, s[32:35], s18 offen lds
s_add_u32 m0, m0, 1024
s_nop 0
buffer_load_dwordx4 v3, s[32:35], s18 offen lds
s_add_u32 m0, s19, 2048
s_add_u32 s18, s16, 16384
buffer_load_dwordx4 v2, s[32:35], s18 offen lds
s_add_u32 m0, m0, 1024
s_nop 0
buffer_load_dwordx4 v3, s[32:35], s18 offen lds
s_add_u32 s16, s16, 128
s_add_u32 m0, s19, 8192
s_add_u32 s18, s17, 0
buffer_load_dwordx4 v4, s[36:39], s18 offen lds
s_add_u32 m0, s19, 9216
s_add_u32 s18, s17, 24576
buffer_load_dwordx4 v4, s[36:39], s18 offen lds
s_add_u32 m0, s19, 10240
s_add_u32 s18, s17, 49152
buffer_load_dwordx4 v4, s[36:39], s18 offen lds
s_add_u32 m0, s19, 11264
s_add_u32 s18, s17, 73728
buffer_load_dwordx4 v4, s[36:39], s18 offen lds
s_add_u32 m0, s19, 16384
s_add_u32 s18, s17, 1024
buffer_load_dwordx4 v4, s[36:39], s18 offen lds
s_add_u32 m0, s19, 17408
s_add_u32 s18, s17, 25600
buffer_load_dwordx4 v4, s[36:39], s18 offen lds
s_add_u32 m0, s19, 18432
s_add_u32 s18, s17, 50176
buffer_load_dwordx4 v4, s[36:39], s18 offen lds
s_add_u32 m0, s19, 19456
s_add_u32 s18, s17, 74752
buffer_load_dwordx4 v4, s[36:39], s18 offen lds
s_add_u32 m0, s19, 24576
s_add_u32 s18, s17, 2048
buffer_load_dwordx4 v4, s[36:39], s18 offen lds
s_add_u32 m0, s19, 25600
s_add_u32 s18, s17, 26624
buffer_load_dwordx4 v4, s[36:39], s18 offen lds
s_add_u32 m0, s19, 26624
s_add_u32 s18, s17, 51200
buffer_load_dwordx4 v4, s[36:39], s18 offen lds
s_add_u32 m0, s19, 27648
s_add_u32 s18, s17, 75776
buffer_load_dwordx4 v4, s[36:39], s18 offen lds
s_add_u32 s17, s17, 196608
s_waitcnt vmcnt(16)
s_barrier
s_add_u32 m0, s19, 32768
s_add_u32 s18, s16, 0
buffer_load_dwordx4 v2, s[32:35], s18 offen lds
s_add_u32 m0, m0, 1024
s_nop 0
buffer_load_dwordx4 v3, s[32:35], s18 offen lds
s_add_u32 m0, s19, 34816
s_add_u32 s18, s16, 16384
buffer_load_dwordx4 v2, s[32:35], s18 offen lds
s_add_u32 m0, m0, 1024
s_nop 0
buffer_load_dwordx4 v3, s[32:35], s18 offen lds
s_add_u32 s16, s16, 128
s_add_u32 m0, s19, 40960
s_add_u32 s18, s17, 0
buffer_load_dwordx4 v4, s[36:39], s18 offen lds
s_add_u32 m0, s19, 41984
s_add_u32 s18, s17, 24576
buffer_load_dwordx4 v4, s[36:39], s18 offen lds
s_add_u32 m0, s19, 43008
s_add_u32 s18, s17, 49152
buffer_load_dwordx4 v4, s[36:39], s18 offen lds
s_add_u32 m0, s19, 44032
s_add_u32 s18, s17, 73728
buffer_load_dwordx4 v4, s[36:39], s18 offen lds
s_add_u32 m0, s19, 49152
s_add_u32 s18, s17, 1024
buffer_load_dwordx4 v4, s[36:39], s18 offen lds
s_add_u32 m0, s19, 50176
s_add_u32 s18, s17, 25600
buffer_load_dwordx4 v4, s[36:39], s18 offen lds
s_add_u32 m0, s19, 51200
s_add_u32 s18, s17, 50176
buffer_load_dwordx4 v4, s[36:39], s18 offen lds
s_add_u32 m0, s19, 52224
s_add_u32 s18, s17, 74752
buffer_load_dwordx4 v4, s[36:39], s18 offen lds
s_add_u32 m0, s19, 57344
s_add_u32 s18, s17, 2048
buffer_load_dwordx4 v4, s[36:39], s18 offen lds
s_add_u32 m0, s19, 58368
s_add_u32 s18, s17, 26624
buffer_load_dwordx4 v4, s[36:39], s18 offen lds
s_add_u32 m0, s19, 59392
s_add_u32 s18, s17, 51200
buffer_load_dwordx4 v4, s[36:39], s18 offen lds
s_add_u32 m0, s19, 60416
s_add_u32 s18, s17, 75776
buffer_load_dwordx4 v4, s[36:39], s18 offen lds
s_add_u32 s17, s17, 196608
s_waitcnt vmcnt(16)
s_barrier
s_add_u32 m0, s19, 65536
s_add_u32 s18, s16, 0
buffer_load_dwordx4 v2, s[32:35], s18 offen lds
s_add_u32 m0, m0, 1024
s_nop 0
buffer_load_dwordx4 v3, s[32:35], s18 offen lds
s_add_u32 m0, s19, 67584
s_add_u32 s18, s16, 16384
buffer_load_dwordx4 v2, s[32:35], s18 offen lds
s_add_u32 m0, m0, 1024
s_nop 0
buffer_load_dwordx4 v3, s[32:35], s18 offen lds
s_add_u32 s16, s16, 128
s_add_u32 m0, s19, 73728
s_add_u32 s18, s17, 0
buffer_load_dwordx4 v4, s[36:39], s18 offen lds
s_add_u32 m0, s19, 74752
s_add_u32 s18, s17, 24576
buffer_load_dwordx4 v4, s[36:39], s18 offen lds
s_add_u32 m0, s19, 75776
s_add_u32 s18, s17, 49152
buffer_load_dwordx4 v4, s[36:39], s18 offen lds
s_add_u32 m0, s19, 76800
s_add_u32 s18, s17, 73728
buffer_load_dwordx4 v4, s[36:39], s18 offen lds
s_add_u32 m0, s19, 81920
s_add_u32 s18, s17, 1024
buffer_load_dwordx4 v4, s[36:39], s18 offen lds
s_add_u32 m0, s19, 82944
s_add_u32 s18, s17, 25600
buffer_load_dwordx4 v4, s[36:39], s18 offen lds
s_add_u32 m0, s19, 83968
s_add_u32 s18, s17, 50176
buffer_load_dwordx4 v4, s[36:39], s18 offen lds
s_add_u32 m0, s19, 84992
s_add_u32 s18, s17, 74752
buffer_load_dwordx4 v4, s[36:39], s18 offen lds
s_add_u32 m0, s19, 90112
s_add_u32 s18, s17, 2048
buffer_load_dwordx4 v4, s[36:39], s18 offen lds
s_add_u32 m0, s19, 91136
s_add_u32 s18, s17, 26624
buffer_load_dwordx4 v4, s[36:39], s18 offen lds
s_add_u32 m0, s19, 92160
s_add_u32 s18, s17, 51200
buffer_load_dwordx4 v4, s[36:39], s18 offen lds
s_add_u32 m0, s19, 93184
s_add_u32 s18, s17, 75776
buffer_load_dwordx4 v4, s[36:39], s18 offen lds
s_add_u32 s17, s17, 196608
s_waitcnt vmcnt(16)
s_barrier
s_add_u32 m0, s19, 98304
s_add_u32 s18, s16, 0
buffer_load_dwordx4 v2, s[32:35], s18 offen lds
s_add_u32 m0, m0, 1024
s_nop 0
buffer_load_dwordx4 v3, s[32:35], s18 offen lds
s_add_u32 m0, s19, 100352
s_add_u32 s18, s16, 16384
buffer_load_dwordx4 v2, s[32:35], s18 offen lds
s_add_u32 m0, m0, 1024
s_nop 0
buffer_load_dwordx4 v3, s[32:35], s18 offen lds
s_add_u32 s16, s16, 128
s_add_u32 m0, s19, 106496
s_add_u32 s18, s17, 0
buffer_load_dwordx4 v4, s[36:39], s18 offen lds
s_add_u32 m0, s19, 107520
s_add_u32 s18, s17, 24576
buffer_load_dwordx4 v4, s[36:39], s18 offen lds
s_add_u32 m0, s19, 108544
s_add_u32 s18, s17, 49152
buffer_load_dwordx4 v4, s[36:39], s18 offen lds
s_add_u32 m0, s19, 109568
s_add_u32 s18, s17, 73728
buffer_load_dwordx4 v4, s[36:39], s18 offen lds
s_add_u32 m0, s19, 114688
s_add_u32 s18, s17, 1024
buffer_load_dwordx4 v4, s[36:39], s18 offen lds
s_add_u32 m0, s19, 115712
s_add_u32 s18, s17, 25600
buffer_load_dwordx4 v4, s[36:39], s18 offen lds
s_add_u32 m0, s19, 116736
s_add_u32 s18, s17, 50176
buffer_load_dwordx4 v4, s[36:39], s18 offen lds
s_add_u32 m0, s19, 117760
s_add_u32 s18, s17, 74752
buffer_load_dwordx4 v4, s[36:39], s18 offen lds
s_add_u32 m0, s19, 122880
s_add_u32 s18, s17, 2048
buffer_load_dwordx4 v4, s[36:39], s18 offen lds
s_add_u32 m0, s19, 123904
s_add_u32 s18, s17, 26624
buffer_load_dwordx4 v4, s[36:39], s18 offen lds
s_add_u32 m0, s19, 124928
s_add_u32 s18, s17, 51200
buffer_load_dwordx4 v4, s[36:39], s18 offen lds
s_add_u32 m0, s19, 125952
s_add_u32 s18, s17, 75776
buffer_load_dwordx4 v4, s[36:39], s18 offen lds
s_add_u32 s17, s17, 196608
s_waitcnt vmcnt(16)
s_barrier
s_waitcnt vmcnt(0)
s_barrier
s_mul_i32 s9, s9, 0x9E3779B1
s_add_u32 s9, s9, 0x7F4A7C15
s_branch gated_mix__linear_kernel_hedgehog__mixer_token_mlp__prompt_kernel_Lm
gated_mix__linear_kernel_hedgehog__mixer_token_mlp__prompt_kernel_LB:
s_mov_b32 s40, s68
s_mov_b32 s41, s69
s_mov_b32 s42, 0x560000
s_mov_b32 s43, 0x20000
s_mul_i32 s16, s12, 22016
s_lshl_b32 s18, s13, 10
s_add_u32 s16, s16, s18
s_add_u32 s19, s18, 133120
s_barrier
s_mov_b32 s27, s16
s_add_u32 m0, s19, 0
s_add_u32 s18, s27, 0
buffer_load_dwordx4 v5, s[40:43], s18 offen nt lds
s_add_u32 m0, s19, 2048
s_add_u32 s18, s27, 2048
buffer_load_dwordx4 v5, s[40:43], s18 offen nt lds
s_add_u32 m0, s19, 4096
s_add_u32 s18, s27, 4096
buffer_load_dwordx4 v5, s[40:43], s18 offen nt lds
s_add_u32 m0, s19, 6144
s_add_u32 s18, s27, 6144
buffer_load_dwordx4 v5, s[40:43], s18 offen nt lds
s_add_u32 m0, s19, 8192
s_add_u32 s18, s27, 8192
buffer_load_dwordx4 v5, s[40:43], s18 offen nt lds
s_add_u32 m0, s19, 10240
s_add_u32 s18, s27, 10240
buffer_load_dwordx4 v5, s[40:43], s18 offen nt lds
s_add_u32 m0, s19, 12288
s_add_u32 s18, s27, 12288
buffer_load_dwordx4 v5, s[40:43], s18 offen nt lds
s_add_u32 m0, s19, 14336
s_add_u32 s18, s27, 14336
buffer_load_dwordx4 v5, s[40:43], s18 offen nt lds
s_add_u32 m0, s19, 16384
s_add_u32 s18, s27, 16384
buffer_load_dwordx4 v5, s[40:43], s18 offen nt lds
s_add_u32 m0, s19, 18432
s_add_u32 s18, s27, 18432
buffer_load_dwordx4 v5, s[40:43], s18 offen nt lds
s_add_u32 m0, s19, 20480
s_add_u32 s18, s27, 20480
buffer_load_dwordx4 v5, s[40:43], s18 offen nt lds
s_add_u32 m0, s19, 22528
s_add_u32 s18, s27, 22528
buffer_load_dwordx4 v5, s[40:43], s18 offen nt lds
s_lshr_b32 s18, s10, 9
s_lshl_b32 s18, s18, 19
s_lshl_b32 s16, s7, 14
s_add_u32 s16, s16, s18
s_lshl_b32 s18, s13, 13
s_add_u32 s16, s16, s18
v_lshlrev_b32 v10, 7, v0
buffer_load_dword v11, v10, s[32:35], s16 offen
s_mul_i32 s16, s7, 49152
s_and_b32 s18, s6, 1
s_lshl_b32 s18, s18, 9
s_add_u32 s16, s16, s18
s_mov_b32 s17, 5462
s_lshl_b32 s18, s13, 6
v_add_u32 v10, s18, v0
v_mul_lo_u32 v12, v10, s17
v_lshrrev_b32 v12, 16, v12
v_mul_u32_u24 v13, 12, v12
v_sub_u32 v13, v10, v13
v_lshrrev_b32 v9, 2, v13
v_and_b32 v13, 3, v13
v_mul_u32_u24 v12, 3072, v12
v_lshl_add_u32 v12, v9, 10, v12
v_lshl_add_u32 v12, v13, 7, v12
buffer_load_dword v11, v12, s[36:39], s16 offen
s_cmp_eq_u32 s13, 0
s_cbranch_scc0 gated_mix__linear_kernel_hedgehog__mixer_token_mlp__prompt_kernel_pfw
v_add_u32 v10, 128, v0
v_mul_lo_u32 v12, v10, s17
v_lshrrev_b32 v12, 16, v12
v_mul_u32_u24 v13, 12, v12
v_sub_u32 v13, v10, v13
v_lshrrev_b32 v9, 2, v13
v_and_b32 v13, 3, v13
v_mul_u32_u24 v12, 3072, v12
v_lshl_add_u32 v12, v9, 10, v12
v_lshl_add_u32 v12, v13, 7, v12
buffer_load_dword v11, v12, s[36:39], s16 offen
gated_mix__linear_kernel_hedgehog__mixer_token_mlp__prompt_kernel_pfw:
v_mov_b32 v14, 159920
v_mov_b32 v15, 1
s_mov_b64 exec, 1
ds_add_u32 v14, v15
s_mov_b64 exec, -1
s_add_u32 s44, s82, 0xf00000
s_addc_u32 s45, s83, 0
s_mov_b32 s46, 0x158000
s_mov_b32 s47, 0x20000
s_mov_b32 s48, s70
s_mov_b32 s49, s71
s_mov_b32 s50, 0xac0
s_mov_b32 s51, 0x20000
s_mov_b32 s52, s72
s_mov_b32 s53, s73
s_mov_b32 s54, 0x560000
s_mov_b32 s55, 0x20000
s_mov_b32 s56, s66
s_mov_b32 s57, s67
s_mov_b32 s58, 0x80000
s_mov_b32 s59, 0x20000
s_waitcnt lgkmcnt(0)
s_mov_b32 s4, 0
s_mul_i32 s9, s9, 0x9E3779B1
s_add_u32 s9, s9, 0x7F4A7C15
s_waitcnt vmcnt(2)
v_mov_b32 v14, 159924
v_mov_b32 v15, 1
s_mov_b64 exec, 1
ds_add_u32 v14, v15
s_mov_b64 exec, -1
v_mov_b32 v14, 159924
s_mov_b32 s25, 0
sw_3:
ds_read_b32 v15, v14
s_add_u32 s25, s25, 1
s_waitcnt lgkmcnt(0)
v_readfirstlane_b32 s24, v15
s_cmp_ge_u32 s24, 2
s_cbranch_scc1 swd_4
s_cmp_lt_u32 s25, 4000000
s_cbranch_scc1 sw_3
swd_4:
v_lshrrev_b32 v6, 4, v0
v_bfe_u32 v7, v0, 2, 2
v_and_b32 v8, 3, v0
v_lshlrev_b32 v8, 3, v8
v_lshl_add_u32 v8, v6, 5, v8
v_mul_u32_u24 v7, 2752, v7
v_add_u32 v8, v7, v8
s_lshl_b32 s18, s13, 7
s_add_u32 s18, s18, 133120
v_add_u32 v8, s18, v8
s_lshl_b32 s18, s13, 5
s_sub_u32 s18, 64, s18
v_cmp_gt_u32 vcc, s18, v0
v_add_u32 v7, 0x40000000, v5
s_mul_i32 s16, s12, 22016
v_cndmask_b32 v7, v7, v5, vcc
s_lshl_b32 s18, s13, 10
s_add_u32 s16, s16, s18
s_add_u32 s16, s16, 0x200000
ds_read_b64_tr_b16 v[16:17], v8 offset:0
ds_read_b64_tr_b16 v[18:19], v8 offset:11008
ds_read_b64_tr_b16 v[20:21], v8 offset:256
ds_read_b64_tr_b16 v[22:23], v8 offset:11264
ds_read_b64_tr_b16 v[24:25], v8 offset:512
ds_read_b64_tr_b16 v[26:27], v8 offset:11520
ds_read_b64_tr_b16 v[28:29], v8 offset:768
ds_read_b64_tr_b16 v[30:31], v8 offset:11776
ds_read_b64_tr_b16 v[32:33], v8 offset:1024
ds_read_b64_tr_b16 v[34:35], v8 offset:12032
ds_read_b64_tr_b16 v[36:37], v8 offset:1280
ds_read_b64_tr_b16 v[38:39], v8 offset:12288
s_waitcnt lgkmcnt(10)
buffer_store_dwordx4 v[16:19], v5, s[28:31], s16 offen sc1
s_add_u32 s16, s16, 2048
ds_read_b64_tr_b16 v[40:41], v8 offset:1536
ds_read_b64_tr_b16 v[42:43], v8 offset:12544
s_waitcnt lgkmcnt(10)
buffer_store_dwordx4 v[20:23], v5, s[28:31], s16 offen sc1
s_add_u32 s16, s16, 2048
ds_read_b64_tr_b16 v[44:45], v8 offset:1792
ds_read_b64_tr_b16 v[46:47], v8 offset:12800
s_waitcnt lgkmcnt(10)
buffer_store_dwordx4 v[24:27], v5, s[28:31], s16 offen sc1
s_add_u32 s16, s16, 2048
ds_read_b64_tr_b16 v[48:49], v8 offset:2048
ds_read_b64_tr_b16 v[50:51], v8 offset:13056
s_waitcnt lgkmcnt(10)
buffer_store_dwordx4 v[28:31], v5, s[28:31], s16 offen sc1
s_add_u32 s16, s16, 2048
ds_read_b64_tr_b16 v[52:53], v8 offset:2304
ds_read_b64_tr_b16 v[54:55], v8 offset:13312
s_waitcnt lgkmcnt(10)
buffer_store_dwordx4 v[32:35], v5, s[28:31], s16 offen sc1
s_add_u32 s16, s16, 2048
ds_read_b64_tr_b16 v[56:57], v8 offset:2560
ds_read_b64_tr_b16 v[58:59], v8 offset:13568
s_waitcnt lgkmcnt(10)
buffer_store_dwordx4 v[36:39], v5, s[28:31], s16 offen sc1
s_add_u32 s16, s16, 2048
s_waitcnt lgkmcnt(8)
buffer_store_dwordx4 v[40:43], v5, s[28:31], s16 offen sc1
s_add_u32 s16, s16, 2048
s_waitcnt lgkmcnt(6)
buffer_store_dwordx4 v[44:47], v5, s[28:31], s16 offen sc1
s_add_u32 s16, s16, 2048
s_waitcnt lgkmcnt(4)
buffer_store_dwordx4 v[48:51], v5, s[28:31], s16 offen sc1
s_add_u32 s16, s16, 2048
s_waitcnt lgkmcnt(2)
buffer_store_dwordx4 v[52:55], v5, s[28:31], s16 offen sc1
s_add_u32 s16, s16, 2048
s_waitcnt lgkmcnt(0)
buffer_store_dwordx4 v[56:59], v7, s[28:31], s16 offen sc1
s_mov_b32 s4, 2
s_mov_b32 s23, 0
lbl_5:
s_barrier
s_cmp_eq_u32 s4, 0
s_cbranch_scc0 lb1_6
s_getreg_b32 s24, hwreg(HW_REG_IB_STS, 0, 4)
s_cmp_eq_u32 s24, 0
s_cbranch_scc0 lbe_8
v_mov_b32 v14, 159924
v_mov_b32 v15, 1
s_mov_b64 exec, 1
ds_add_u32 v14, v15
s_mov_b64 exec, -1
s_mov_b32 s4, 1
lb1_6:
s_cmp_eq_u32 s4, 1
s_cbranch_scc0 lb2_7
v_mov_b32 v14, 159924
ds_read_b32 v15, v14
s_waitcnt lgkmcnt(0)
v_readfirstlane_b32 s24, v15
s_cmp_ge_u32 s24, 2
s_cbranch_scc0 lbe_8
v_lshrrev_b32 v6, 4, v0
v_bfe_u32 v7, v0, 2, 2
v_and_b32 v8, 3, v0
v_lshlrev_b32 v8, 3, v8
v_lshl_add_u32 v8, v6, 5, v8
v_mul_u32_u24 v7, 2752, v7
v_add_u32 v8, v7, v8
s_lshl_b32 s18, s13, 7
s_add_u32 s18, s18, 133120
v_add_u32 v8, s18, v8
s_lshl_b32 s18, s13, 5
s_sub_u32 s18, 64, s18
v_cmp_gt_u32 vcc, s18, v0
v_add_u32 v7, 0x40000000, v5
s_mul_i32 s16, s12, 22016
v_cndmask_b32 v7, v7, v5, vcc
s_lshl_b32 s18, s13, 10
s_add_u32 s16, s16, s18
s_add_u32 s16, s16, 0x200000
ds_read_b64_tr_b16 v[16:17], v8 offset:0
ds_read_b64_tr_b16 v[18:19], v8 offset:11008
ds_read_b64_tr_b16 v[20:21], v8 offset:256
ds_read_b64_tr_b16 v[22:23], v8 offset:11264
ds_read_b64_tr_b16 v[24:25], v8 offset:512
ds_read_b64_tr_b16 v[26:27], v8 offset:11520
ds_read_b64_tr_b16 v[28:29], v8 offset:768
ds_read_b64_tr_b16 v[30:31], v8 offset:11776
ds_read_b64_tr_b16 v[32:33], v8 offset:1024
ds_read_b64_tr_b16 v[34:35], v8 offset:12032
ds_read_b64_tr_b16 v[36:37], v8 offset:1280
ds_read_b64_tr_b16 v[38:39], v8 offset:12288
s_waitcnt lgkmcnt(10)
buffer_store_dwordx4 v[16:19], v5, s[28:31], s16 offen sc1
s_add_u32 s16, s16, 2048
ds_read_b64_tr_b16 v[40:41], v8 offset:1536
ds_read_b64_tr_b16 v[42:43], v8 offset:12544
s_waitcnt lgkmcnt(10)
buffer_store_dwordx4 v[20:23], v5, s[28:31], s16 offen sc1
s_add_u32 s16, s16, 2048
ds_read_b64_tr_b16 v[44:45], v8 offset:1792
ds_read_b64_tr_b16 v[46:47], v8 offset:12800
s_waitcnt lgkmcnt(10)
buffer_store_dwordx4 v[24:27], v5, s[28:31], s16 offen sc1
s_add_u32 s16, s16, 2048
ds_read_b64_tr_b16 v[48:49], v8 offset:2048
ds_read_b64_tr_b16 v[50:51], v8 offset:13056
s_waitcnt lgkmcnt(10)
buffer_store_dwordx4 v[28:31], v5, s[28:31], s16 offen sc1
s_add_u32 s16, s16, 2048
ds_read_b64_tr_b16 v[52:53], v8 offset:2304
ds_read_b64_tr_b16 v[54:55], v8 offset:13312
s_waitcnt lgkmcnt(10)
buffer_store_dwordx4 v[32:35], v5, s[28:31], s16 offen sc1
s_add_u32 s16, s16, 2048
ds_read_b64_tr_b16 v[56:57], v8 offset:2560
ds_read_b64_tr_b16 v[58:59], v8 offset:13568
s_waitcnt lgkmcnt(10)
buffer_store_dwordx4 v[36:39], v5, s[28:31], s16 offen sc1
s_add_u32 s16, s16, 2048
s_waitcnt lgkmcnt(8)
buffer_store_dwordx4 v[40:43], v5, s[28:31], s16 offen sc1
s_add_u32 s16, s16, 2048
s_waitcnt lgkmcnt(6)
buffer_store_dwordx4 v[44:47], v5, s[28:31], s16 offen sc1
s_add_u32 s16, s16, 2048
s_waitcnt lgkmcnt(4)
buffer_store_dwordx4 v[48:51], v5, s[28:31], s16 offen sc1
s_add_u32 s16, s16, 2048
s_waitcnt lgkmcnt(2)
buffer_store_dwordx4 v[52:55], v5, s[28:31], s16 offen sc1
s_add_u32 s16, s16, 2048
s_waitcnt lgkmcnt(0)
buffer_store_dwordx4 v[56:59], v7, s[28:31], s16 offen sc1
s_mov_b32 s4, 2
s_branch lbe_8
lb2_7:
s_cmp_eq_u32 s4, 2
s_cbranch_scc0 lbe_8
s_getreg_b32 s24, hwreg(HW_REG_IB_STS, 0, 4)
s_cmp_eq_u32 s24, 0
s_cbranch_scc0 lbe_8
s_mov_b32 s4, 3
v_mov_b32 v14, 159908
v_mov_b32 v15, 1
s_mov_b64 exec, 1
ds_add_rtn_u32 v15, v14, v15
s_mov_b64 exec, -1
s_waitcnt lgkmcnt(0)
v_readfirstlane_b32 s24, v15
s_cmp_eq_u32 s24, 5
s_cbranch_scc0 lbe_8
s_lshl_b32 s24, s12, 6
s_add_u32 s24, s24, 0x1801000
v_mov_b32 v14, s9
v_mov_b32 v15, 0
s_mov_b64 exec, 1
buffer_store_dword v14, v15, s[28:31], s24 offen sc1
s_mov_b64 exec, -1
lbe_8:
s_add_u32 s23, s23, 1
s_cmp_lt_u32 s23, 6
s_cbranch_scc1 lbl_5
s_barrier
s_cmp_eq_u32 s4, 0
s_cbranch_scc0 lb1_9
s_waitcnt vmcnt(0)
v_mov_b32 v14, 159924
v_mov_b32 v15, 1
s_mov_b64 exec, 1
ds_add_u32 v14, v15
s_mov_b64 exec, -1
s_mov_b32 s4, 1
lb1_9:
s_cmp_eq_u32 s4, 1
s_cbranch_scc0 lb2_10
v_mov_b32 v14, 159924
s_mov_b32 s25, 0
sw_12:
ds_read_b32 v15, v14
s_add_u32 s25, s25, 1
s_waitcnt lgkmcnt(0)
v_readfirstlane_b32 s24, v15
s_cmp_ge_u32 s24, 2
s_cbranch_scc1 swd_13
s_cmp_lt_u32 s25, 4000000
s_cbranch_scc1 sw_12
swd_13:
v_lshrrev_b32 v6, 4, v0
v_bfe_u32 v7, v0, 2, 2
v_and_b32 v8, 3, v0
v_lshlrev_b32 v8, 3, v8
v_lshl_add_u32 v8, v6, 5, v8
v_mul_u32_u24 v7, 2752, v7
v_add_u32 v8, v7, v8
s_lshl_b32 s18, s13, 7
s_add_u32 s18, s18, 133120
v_add_u32 v8, s18, v8
s_lshl_b32 s18, s13, 5
s_sub_u32 s18, 64, s18
v_cmp_gt_u32 vcc, s18, v0
v_add_u32 v7, 0x40000000, v5
s_mul_i32 s16, s12, 22016
v_cndmask_b32 v7, v7, v5, vcc
s_lshl_b32 s18, s13, 10
s_add_u32 s16, s16, s18
s_add_u32 s16, s16, 0x200000
ds_read_b64_tr_b16 v[16:17], v8 offset:0
ds_read_b64_tr_b16 v[18:19], v8 offset:11008
ds_read_b64_tr_b16 v[20:21], v8 offset:256
ds_read_b64_tr_b16 v[22:23], v8 offset:11264
ds_read_b64_tr_b16 v[24:25], v8 offset:512
ds_read_b64_tr_b16 v[26:27], v8 offset:11520
ds_read_b64_tr_b16 v[28:29], v8 offset:768
ds_read_b64_tr_b16 v[30:31], v8 offset:11776
ds_read_b64_tr_b16 v[32:33], v8 offset:1024
ds_read_b64_tr_b16 v[34:35], v8 offset:12032
ds_read_b64_tr_b16 v[36:37], v8 offset:1280
ds_read_b64_tr_b16 v[38:39], v8 offset:12288
s_waitcnt lgkmcnt(10)
buffer_store_dwordx4 v[16:19], v5, s[28:31], s16 offen sc1
s_add_u32 s16, s16, 2048
ds_read_b64_tr_b16 v[40:41], v8 offset:1536
ds_read_b64_tr_b16 v[42:43], v8 offset:12544
s_waitcnt lgkmcnt(10)
buffer_store_dwordx4 v[20:23], v5, s[28:31], s16 offen sc1
s_add_u32 s16, s16, 2048
ds_read_b64_tr_b16 v[44:45], v8 offset:1792
ds_read_b64_tr_b16 v[46:47], v8 offset:12800
s_waitcnt lgkmcnt(10)
buffer_store_dwordx4 v[24:27], v5, s[28:31], s16 offen sc1
s_add_u32 s16, s16, 2048
ds_read_b64_tr_b16 v[48:49], v8 offset:2048
ds_read_b64_tr_b16 v[50:51], v8 offset:13056
s_waitcnt lgkmcnt(10)
buffer_store_dwordx4 v[28:31], v5, s[28:31], s16 offen sc1
s_add_u32 s16, s16, 2048
ds_read_b64_tr_b16 v[52:53], v8 offset:2304
ds_read_b64_tr_b16 v[54:55], v8 offset:13312
s_waitcnt lgkmcnt(10)
buffer_store_dwordx4 v[32:35], v5, s[28:31], s16 offen sc1
s_add_u32 s16, s16, 2048
ds_read_b64_tr_b16 v[56:57], v8 offset:2560
ds_read_b64_tr_b16 v[58:59], v8 offset:13568
s_waitcnt lgkmcnt(10)
buffer_store_dwordx4 v[36:39], v5, s[28:31], s16 offen sc1
s_add_u32 s16, s16, 2048
s_waitcnt lgkmcnt(8)
buffer_store_dwordx4 v[40:43], v5, s[28:31], s16 offen sc1
s_add_u32 s16, s16, 2048
s_waitcnt lgkmcnt(6)
buffer_store_dwordx4 v[44:47], v5, s[28:31], s16 offen sc1
s_add_u32 s16, s16, 2048
s_waitcnt lgkmcnt(4)
buffer_store_dwordx4 v[48:51], v5, s[28:31], s16 offen sc1
s_add_u32 s16, s16, 2048
s_waitcnt lgkmcnt(2)
buffer_store_dwordx4 v[52:55], v5, s[28:31], s16 offen sc1
s_add_u32 s16, s16, 2048
s_waitcnt lgkmcnt(0)
buffer_store_dwordx4 v[56:59], v7, s[28:31], s16 offen sc1
s_mov_b32 s4, 2
lb2_10:
s_cmp_eq_u32 s4, 2
s_cbranch_scc0 lbe_11
s_waitcnt vmcnt(0)
s_mov_b32 s4, 3
v_mov_b32 v14, 159908
v_mov_b32 v15, 1
s_mov_b64 exec, 1
ds_add_rtn_u32 v15, v14, v15
s_mov_b64 exec, -1
s_waitcnt lgkmcnt(0)
v_readfirstlane_b32 s24, v15
s_cmp_eq_u32 s24, 5
s_cbranch_scc0 lbe_11
s_lshl_b32 s24, s12, 6
s_add_u32 s24, s24, 0x1801000
v_mov_b32 v14, s9
v_mov_b32 v15, 0
s_mov_b64 exec, 1
buffer_store_dword v14, v15, s[28:31], s24 offen sc1
s_mov_b64 exec, -1
lbe_11:
s_cmp_ge_u32 s7, 22
s_cbranch_scc0 nw2_14
s_sub_u32 s16, s7, 22
s_lshl_b32 s16, s16, 1
s_add_u32 s16, s16, s13
s_lshl_b32 s16, s16, 6
v_add_u32 v8, s16, v0
s_lshl_b32 s18, s6, 9
v_add_u32 v9, 0, v8
v_and_b32 v12, 3, v9
v_lshrrev_b32 v9, 2, v9
v_lshlrev_b32 v9, 12, v9
v_lshl_add_u32 v9, v12, 7, v9
buffer_load_dword v13, v9, s[52:55], s18 offen
v_add_u32 v9, 1280, v8
v_and_b32 v12, 3, v9
v_lshrrev_b32 v9, 2, v9
v_lshlrev_b32 v9, 12, v9
v_lshl_add_u32 v9, v12, 7, v9
buffer_load_dword v13, v9, s[52:55], s18 offen
nw2_14:
s_barrier
gated_mix__linear_kernel_hedgehog__mixer_token_mlp__prompt_kernel_Lm:
s_waitcnt lgkmcnt(0)
v_lshrrev_b32 v10, 1, v0
v_lshlrev_b32 v10, 3, v10
v_and_b32 v11, 1, v0
v_add_u32 v10, v10, v11
s_lshl_b32 s18, s8, 1
v_add_u32 v10, s18, v10
v_lshlrev_b32 v10, 6, v10
s_mov_b32 s23, 0x1801000
s_cmp_ge_u32 s7, 22
s_cbranch_scc1 gated_mix__linear_kernel_hedgehog__mixer_token_mlp__prompt_kernel_spare
v_and_b32 v12, 31, v0
v_lshrrev_b32 v13, 5, v0
v_lshlrev_b32 v12, 4, v12
v_lshl_add_u32 v3, v13, 13, v12
v_mul_u32_u24 v14, 22016, v13
v_add_u32 v2, v14, v12
s_mul_i32 s17, s8, 44032
s_lshl_b32 s18, s21, 10
s_add_u32 s17, s17, s18
s_add_u32 s17, s17, 0x200000
s_lshl_b32 s16, s8, 14
s_lshl_b32 s18, s22, 10
s_add_u32 s16, s16, s18
s_add_u32 s16, s16, 0x0
s_mov_b32 s26, 0
pl_15:
buffer_load_dword v11, v10, s[28:31], s23 offen sc1
s_waitcnt vmcnt(0)
v_cmp_eq_u32 s[4:5], s9, v11
s_add_u32 s26, s26, 1
s_nop 0
s_lshr_b64 s[24:25], s[4:5], 0
s_and_b32 s24, s24, 3
s_cmp_eq_u32 s24, 3
s_cbranch_scc1 plok_16
s_cmp_lt_u32 s26, 60000
s_cbranch_scc1 pl_15
plok_16:
s_lshr_b64 s[24:25], s[4:5], 0
s_and_b32 s24, s24, 3
s_cmp_eq_u32 s24, 3
s_cbranch_scc1 stok_17
s_mov_b32 s26, 0
pl_18:
buffer_load_dword v11, v10, s[28:31], s23 offen sc1
s_waitcnt vmcnt(0)
v_cmp_eq_u32 s[4:5], s9, v11
s_add_u32 s26, s26, 1
s_nop 0
s_lshr_b64 s[24:25], s[4:5], 0
s_and_b32 s24, s24, 3
s_cmp_eq_u32 s24, 3
s_cbranch_scc1 plok_19
s_cmp_lt_u32 s26, 60000
s_cbranch_scc1 pl_18
plok_19:
stok_17:
buffer_load_dwordx4 v[16:19], v2, s[28:31], s17 offen offset:0 sc1
buffer_load_dwordx4 v[20:23], v2, s[28:31], s17 offen offset:512 sc1
buffer_load_dwordx4 v[24:27], v3, s[28:31], s16 offen offset:0 sc1
buffer_load_dwordx4 v[28:31], v3, s[28:31], s16 offen offset:512 sc1
s_add_u32 s17, s17, 176128
s_add_u32 s16, s16, 65536
s_lshr_b64 s[24:25], s[4:5], 2
s_and_b32 s24, s24, 3
s_cmp_eq_u32 s24, 3
s_cbranch_scc1 stok_20
s_mov_b32 s26, 0
pl_21:
buffer_load_dword v11, v10, s[28:31], s23 offen sc1
s_waitcnt vmcnt(0)
v_cmp_eq_u32 s[4:5], s9, v11
s_add_u32 s26, s26, 1
s_nop 0
s_lshr_b64 s[24:25], s[4:5], 2
s_and_b32 s24, s24, 3
s_cmp_eq_u32 s24, 3
s_cbranch_scc1 plok_22
s_cmp_lt_u32 s26, 60000
s_cbranch_scc1 pl_21
plok_22:
stok_20:
buffer_load_dwordx4 v[32:35], v2, s[28:31], s17 offen offset:0 sc1
buffer_load_dwordx4 v[36:39], v2, s[28:31], s17 offen offset:512 sc1
buffer_load_dwordx4 v[40:43], v3, s[28:31], s16 offen offset:0 sc1
buffer_load_dwordx4 v[44:47], v3, s[28:31], s16 offen offset:512 sc1
s_add_u32 s17, s17, 176128
s_add_u32 s16, s16, 65536
s_lshr_b64 s[24:25], s[4:5], 4
s_and_b32 s24, s24, 3
s_cmp_eq_u32 s24, 3
s_cbranch_scc1 stok_23
s_mov_b32 s26, 0
pl_24:
buffer_load_dword v11, v10, s[28:31], s23 offen sc1
s_waitcnt vmcnt(0)
v_cmp_eq_u32 s[4:5], s9, v11
s_add_u32 s26, s26, 1
s_nop 0
s_lshr_b64 s[24:25], s[4:5], 4
s_and_b32 s24, s24, 3
s_cmp_eq_u32 s24, 3
s_cbranch_scc1 plok_25
s_cmp_lt_u32 s26, 60000
s_cbranch_scc1 pl_24
plok_25:
stok_23:
buffer_load_dwordx4 v[48:51], v2, s[28:31], s17 offen offset:0 sc1
buffer_load_dwordx4 v[52:55], v2, s[28:31], s17 offen offset:512 sc1
buffer_load_dwordx4 v[56:59], v3, s[28:31], s16 offen offset:0 sc1
buffer_load_dwordx4 v[60:63], v3, s[28:31], s16 offen offset:512 sc1
s_add_u32 s17, s17, 176128
s_add_u32 s16, s16, 65536
s_lshr_b64 s[24:25], s[4:5], 6
s_and_b32 s24, s24, 3
s_cmp_eq_u32 s24, 3
s_cbranch_scc1 stok_26
s_mov_b32 s26, 0
pl_27:
buffer_load_dword v11, v10, s[28:31], s23 offen sc1
s_waitcnt vmcnt(0)
v_cmp_eq_u32 s[4:5], s9, v11
s_add_u32 s26, s26, 1
s_nop 0
s_lshr_b64 s[24:25], s[4:5], 6
s_and_b32 s24, s24, 3
s_cmp_eq_u32 s24, 3
s_cbranch_scc1 plok_28
s_cmp_lt_u32 s26, 60000
s_cbranch_scc1 pl_27
plok_28:
stok_26:
buffer_load_dwordx4 v[64:67], v2, s[28:31], s17 offen offset:0 sc1
buffer_load_dwordx4 v[68:71], v2, s[28:31], s17 offen offset:512 sc1
buffer_load_dwordx4 v[72:75], v3, s[28:31], s16 offen offset:0 sc1
buffer_load_dwordx4 v[76:79], v3, s[28:31], s16 offen offset:512 sc1
s_add_u32 s17, s17, 176128
s_add_u32 s16, s16, 65536
v_lshrrev_b32 v13, 5, v0
s_lshr_b32 s18, s8, 1
s_lshl_b32 s18, s18, 5
s_lshl_b32 s27, s21, 6
s_add_u32 s18, s18, s27
v_lshlrev_b32 v12, 3, v13
s_lshl_b32 s27, s18, 1
v_add_u32 v12, s27, v12
buffer_load_dwordx2 v[192:193], v12, s[48:51], 0 offen offset:0
buffer_load_dwordx2 v[194:195], v12, s[48:51], 0 offen offset:16
buffer_load_dwordx2 v[196:197], v12, s[48:51], 0 offen offset:32
buffer_load_dwordx2 v[198:199], v12, s[48:51], 0 offen offset:48
s_lshr_b32 s18, s18, 3
v_add_u32 v12, s18, v13
v_lshlrev_b32 v12, 9, v12
s_and_b32 s18, s8, 1
s_lshl_b32 s18, s18, 5
s_lshl_b32 s27, s22, 6
s_add_u32 s18, s18, s27
v_and_b32 v13, 31, v0
v_add3_u32 v12, v12, v13, s18
v_lshlrev_b32 v200, 4, v12
s_waitcnt vmcnt(16)
v_mfma_f32_32x32x16_bf16 v[80:95], v[16:19], v[24:27], 0
v_mfma_f32_32x32x16_bf16 v[96:111], v[16:19], v[28:31], 0
v_mfma_f32_32x32x16_bf16 v[112:127], v[20:23], v[24:27], 0
v_mfma_f32_32x32x16_bf16 v[128:143], v[20:23], v[28:31], 0
s_lshr_b64 s[24:25], s[4:5], 8
s_and_b32 s24, s24, 3
s_cmp_eq_u32 s24, 3
s_cbranch_scc1 stok_29
s_mov_b32 s26, 0
pl_30:
buffer_load_dword v11, v10, s[28:31], s23 offen sc1
s_waitcnt vmcnt(0)
v_cmp_eq_u32 s[4:5], s9, v11
s_add_u32 s26, s26, 1
s_nop 0
s_lshr_b64 s[24:25], s[4:5], 8
s_and_b32 s24, s24, 3
s_cmp_eq_u32 s24, 3
s_cbranch_scc1 plok_31
s_cmp_lt_u32 s26, 60000
s_cbranch_scc1 pl_30
plok_31:
stok_29:
buffer_load_dwordx4 v[16:19], v2, s[28:31], s17 offen offset:0 sc1
buffer_load_dwordx4 v[20:23], v2, s[28:31], s17 offen offset:512 sc1
buffer_load_dwordx4 v[24:27], v3, s[28:31], s16 offen offset:0 sc1
buffer_load_dwordx4 v[28:31], v3, s[28:31], s16 offen offset:512 sc1
s_add_u32 s17, s17, 176128
s_add_u32 s16, s16, 65536
s_waitcnt vmcnt(16)
v_mfma_f32_32x32x16_bf16 v[80:95], v[32:35], v[40:43], v[80:95]
v_mfma_f32_32x32x16_bf16 v[96:111], v[32:35], v[44:47], v[96:111]
v_mfma_f32_32x32x16_bf16 v[112:127], v[36:39], v[40:43], v[112:127]
v_mfma_f32_32x32x16_bf16 v[128:143], v[36:39], v[44:47], v[128:143]
s_lshr_b64 s[24:25], s[4:5], 10
s_and_b32 s24, s24, 3
s_cmp_eq_u32 s24, 3
s_cbranch_scc1 stok_32
s_mov_b32 s26, 0
pl_33:
buffer_load_dword v11, v10, s[28:31], s23 offen sc1
s_waitcnt vmcnt(0)
v_cmp_eq_u32 s[4:5], s9, v11
s_add_u32 s26, s26, 1
s_nop 0
s_lshr_b64 s[24:25], s[4:5], 10
s_and_b32 s24, s24, 3
s_cmp_eq_u32 s24, 3
s_cbranch_scc1 plok_34
s_cmp_lt_u32 s26, 60000
s_cbranch_scc1 pl_33
plok_34:
stok_32:
buffer_load_dwordx4 v[32:35], v2, s[28:31], s17 offen offset:0 sc1
buffer_load_dwordx4 v[36:39], v2, s[28:31], s17 offen offset:512 sc1
buffer_load_dwordx4 v[40:43], v3, s[28:31], s16 offen offset:0 sc1
buffer_load_dwordx4 v[44:47], v3, s[28:31], s16 offen offset:512 sc1
s_add_u32 s17, s17, 176128
s_add_u32 s16, s16, 65536
s_waitcnt vmcnt(16)
v_mfma_f32_32x32x16_bf16 v[80:95], v[48:51], v[56:59], v[80:95]
v_mfma_f32_32x32x16_bf16 v[96:111], v[48:51], v[60:63], v[96:111]
v_mfma_f32_32x32x16_bf16 v[112:127], v[52:55], v[56:59], v[112:127]
v_mfma_f32_32x32x16_bf16 v[128:143], v[52:55], v[60:63], v[128:143]
s_lshr_b64 s[24:25], s[4:5], 12
s_and_b32 s24, s24, 3
s_cmp_eq_u32 s24, 3
s_cbranch_scc1 stok_35
s_mov_b32 s26, 0
pl_36:
buffer_load_dword v11, v10, s[28:31], s23 offen sc1
s_waitcnt vmcnt(0)
v_cmp_eq_u32 s[4:5], s9, v11
s_add_u32 s26, s26, 1
s_nop 0
s_lshr_b64 s[24:25], s[4:5], 12
s_and_b32 s24, s24, 3
s_cmp_eq_u32 s24, 3
s_cbranch_scc1 plok_37
s_cmp_lt_u32 s26, 60000
s_cbranch_scc1 pl_36
plok_37:
stok_35:
buffer_load_dwordx4 v[48:51], v2, s[28:31], s17 offen offset:0 sc1
buffer_load_dwordx4 v[52:55], v2, s[28:31], s17 offen offset:512 sc1
buffer_load_dwordx4 v[56:59], v3, s[28:31], s16 offen offset:0 sc1
buffer_load_dwordx4 v[60:63], v3, s[28:31], s16 offen offset:512 sc1
s_add_u32 s17, s17, 176128
s_add_u32 s16, s16, 65536
s_waitcnt vmcnt(16)
v_mfma_f32_32x32x16_bf16 v[80:95], v[64:67], v[72:75], v[80:95]
v_mfma_f32_32x32x16_bf16 v[96:111], v[64:67], v[76:79], v[96:111]
v_mfma_f32_32x32x16_bf16 v[112:127], v[68:71], v[72:75], v[112:127]
v_mfma_f32_32x32x16_bf16 v[128:143], v[68:71], v[76:79], v[128:143]
s_lshr_b64 s[24:25], s[4:5], 14
s_and_b32 s24, s24, 3
s_cmp_eq_u32 s24, 3
s_cbranch_scc1 stok_38
s_mov_b32 s26, 0
pl_39:
buffer_load_dword v11, v10, s[28:31], s23 offen sc1
s_waitcnt vmcnt(0)
v_cmp_eq_u32 s[4:5], s9, v11
s_add_u32 s26, s26, 1
s_nop 0
s_lshr_b64 s[24:25], s[4:5], 14
s_and_b32 s24, s24, 3
s_cmp_eq_u32 s24, 3
s_cbranch_scc1 plok_40
s_cmp_lt_u32 s26, 60000
s_cbranch_scc1 pl_39
plok_40:
stok_38:
buffer_load_dwordx4 v[64:67], v2, s[28:31], s17 offen offset:0 sc1
buffer_load_dwordx4 v[68:71], v2, s[28:31], s17 offen offset:512 sc1
buffer_load_dwordx4 v[72:75], v3, s[28:31], s16 offen offset:0 sc1
buffer_load_dwordx4 v[76:79], v3, s[28:31], s16 offen offset:512 sc1
s_add_u32 s17, s17, 176128
s_add_u32 s16, s16, 65536
s_waitcnt vmcnt(12)
v_mfma_f32_32x32x16_bf16 v[80:95], v[16:19], v[24:27], v[80:95]
v_mfma_f32_32x32x16_bf16 v[96:111], v[16:19], v[28:31], v[96:111]
v_mfma_f32_32x32x16_bf16 v[112:127], v[20:23], v[24:27], v[112:127]
v_mfma_f32_32x32x16_bf16 v[128:143], v[20:23], v[28:31], v[128:143]
s_lshr_b64 s[24:25], s[4:5], 16
s_and_b32 s24, s24, 3
s_cmp_eq_u32 s24, 3
s_cbranch_scc1 stok_41
s_mov_b32 s26, 0
pl_42:
buffer_load_dword v11, v10, s[28:31], s23 offen sc1
s_waitcnt vmcnt(0)
v_cmp_eq_u32 s[4:5], s9, v11
s_add_u32 s26, s26, 1
s_nop 0
s_lshr_b64 s[24:25], s[4:5], 16
s_and_b32 s24, s24, 3
s_cmp_eq_u32 s24, 3
s_cbranch_scc1 plok_43
s_cmp_lt_u32 s26, 60000
s_cbranch_scc1 pl_42
plok_43:
stok_41:
buffer_load_dwordx4 v[16:19], v2, s[28:31], s17 offen offset:0 sc1
buffer_load_dwordx4 v[20:23], v2, s[28:31], s17 offen offset:512 sc1
buffer_load_dwordx4 v[24:27], v3, s[28:31], s16 offen offset:0 sc1
buffer_load_dwordx4 v[28:31], v3, s[28:31], s16 offen offset:512 sc1
s_add_u32 s17, s17, 176128
s_add_u32 s16, s16, 65536
s_waitcnt vmcnt(12)
v_mfma_f32_32x32x16_bf16 v[80:95], v[32:35], v[40:43], v[80:95]
v_mfma_f32_32x32x16_bf16 v[96:111], v[32:35], v[44:47], v[96:111]
v_mfma_f32_32x32x16_bf16 v[112:127], v[36:39], v[40:43], v[112:127]
v_mfma_f32_32x32x16_bf16 v[128:143], v[36:39], v[44:47], v[128:143]
s_lshr_b64 s[24:25], s[4:5], 18
s_and_b32 s24, s24, 3
s_cmp_eq_u32 s24, 3
s_cbranch_scc1 stok_44
s_mov_b32 s26, 0
pl_45:
buffer_load_dword v11, v10, s[28:31], s23 offen sc1
s_waitcnt vmcnt(0)
v_cmp_eq_u32 s[4:5], s9, v11
s_add_u32 s26, s26, 1
s_nop 0
s_lshr_b64 s[24:25], s[4:5], 18
s_and_b32 s24, s24, 3
s_cmp_eq_u32 s24, 3
s_cbranch_scc1 plok_46
s_cmp_lt_u32 s26, 60000
s_cbranch_scc1 pl_45
plok_46:
stok_44:
buffer_load_dwordx4 v[32:35], v2, s[28:31], s17 offen offset:0 sc1
buffer_load_dwordx4 v[36:39], v2, s[28:31], s17 offen offset:512 sc1
buffer_load_dwordx4 v[40:43], v3, s[28:31], s16 offen offset:0 sc1
buffer_load_dwordx4 v[44:47], v3, s[28:31], s16 offen offset:512 sc1
s_add_u32 s17, s17, 176128
s_add_u32 s16, s16, 65536
s_waitcnt vmcnt(12)
v_mfma_f32_32x32x16_bf16 v[80:95], v[48:51], v[56:59], v[80:95]
v_mfma_f32_32x32x16_bf16 v[96:111], v[48:51], v[60:63], v[96:111]
v_mfma_f32_32x32x16_bf16 v[112:127], v[52:55], v[56:59], v[112:127]
v_mfma_f32_32x32x16_bf16 v[128:143], v[52:55], v[60:63], v[128:143]
s_lshr_b64 s[24:25], s[4:5], 20
s_and_b32 s24, s24, 3
s_cmp_eq_u32 s24, 3
s_cbranch_scc1 stok_47
s_mov_b32 s26, 0
pl_48:
buffer_load_dword v11, v10, s[28:31], s23 offen sc1
s_waitcnt vmcnt(0)
v_cmp_eq_u32 s[4:5], s9, v11
s_add_u32 s26, s26, 1
s_nop 0
s_lshr_b64 s[24:25], s[4:5], 20
s_and_b32 s24, s24, 3
s_cmp_eq_u32 s24, 3
s_cbranch_scc1 plok_49
s_cmp_lt_u32 s26, 60000
s_cbranch_scc1 pl_48
plok_49:
stok_47:
buffer_load_dwordx4 v[48:51], v2, s[28:31], s17 offen offset:0 sc1
buffer_load_dwordx4 v[52:55], v2, s[28:31], s17 offen offset:512 sc1
buffer_load_dwordx4 v[56:59], v3, s[28:31], s16 offen offset:0 sc1
buffer_load_dwordx4 v[60:63], v3, s[28:31], s16 offen offset:512 sc1
s_add_u32 s17, s17, 176128
s_add_u32 s16, s16, 65536
s_waitcnt vmcnt(12)
v_mfma_f32_32x32x16_bf16 v[80:95], v[64:67], v[72:75], v[80:95]
v_mfma_f32_32x32x16_bf16 v[96:111], v[64:67], v[76:79], v[96:111]
v_mfma_f32_32x32x16_bf16 v[112:127], v[68:71], v[72:75], v[112:127]
v_mfma_f32_32x32x16_bf16 v[128:143], v[68:71], v[76:79], v[128:143]
s_lshr_b64 s[24:25], s[4:5], 22
s_and_b32 s24, s24, 3
s_cmp_eq_u32 s24, 3
s_cbranch_scc1 stok_50
s_mov_b32 s26, 0
pl_51:
buffer_load_dword v11, v10, s[28:31], s23 offen sc1
s_waitcnt vmcnt(0)
v_cmp_eq_u32 s[4:5], s9, v11
s_add_u32 s26, s26, 1
s_nop 0
s_lshr_b64 s[24:25], s[4:5], 22
s_and_b32 s24, s24, 3
s_cmp_eq_u32 s24, 3
s_cbranch_scc1 plok_52
s_cmp_lt_u32 s26, 60000
s_cbranch_scc1 pl_51
plok_52:
stok_50:
buffer_load_dwordx4 v[64:67], v2, s[28:31], s17 offen offset:0 sc1
buffer_load_dwordx4 v[68:71], v2, s[28:31], s17 offen offset:512 sc1
buffer_load_dwordx4 v[72:75], v3, s[28:31], s16 offen offset:0 sc1
buffer_load_dwordx4 v[76:79], v3, s[28:31], s16 offen offset:512 sc1
s_add_u32 s17, s17, 176128
s_add_u32 s16, s16, 65536
s_waitcnt vmcnt(12)
v_mfma_f32_32x32x16_bf16 v[80:95], v[16:19], v[24:27], v[80:95]
v_mfma_f32_32x32x16_bf16 v[96:111], v[16:19], v[28:31], v[96:111]
v_mfma_f32_32x32x16_bf16 v[112:127], v[20:23], v[24:27], v[112:127]
v_mfma_f32_32x32x16_bf16 v[128:143], v[20:23], v[28:31], v[128:143]
s_lshr_b64 s[24:25], s[4:5], 24
s_and_b32 s24, s24, 3
s_cmp_eq_u32 s24, 3
s_cbranch_scc1 stok_53
s_mov_b32 s26, 0
pl_54:
buffer_load_dword v11, v10, s[28:31], s23 offen sc1
s_waitcnt vmcnt(0)
v_cmp_eq_u32 s[4:5], s9, v11
s_add_u32 s26, s26, 1
s_nop 0
s_lshr_b64 s[24:25], s[4:5], 24
s_and_b32 s24, s24, 3
s_cmp_eq_u32 s24, 3
s_cbranch_scc1 plok_55
s_cmp_lt_u32 s26, 60000
s_cbranch_scc1 pl_54
plok_55:
stok_53:
buffer_load_dwordx4 v[16:19], v2, s[28:31], s17 offen offset:0 sc1
buffer_load_dwordx4 v[20:23], v2, s[28:31], s17 offen offset:512 sc1
buffer_load_dwordx4 v[24:27], v3, s[28:31], s16 offen offset:0 sc1
buffer_load_dwordx4 v[28:31], v3, s[28:31], s16 offen offset:512 sc1
s_add_u32 s17, s17, 176128
s_add_u32 s16, s16, 65536
s_waitcnt vmcnt(12)
v_mfma_f32_32x32x16_bf16 v[80:95], v[32:35], v[40:43], v[80:95]
v_mfma_f32_32x32x16_bf16 v[96:111], v[32:35], v[44:47], v[96:111]
v_mfma_f32_32x32x16_bf16 v[112:127], v[36:39], v[40:43], v[112:127]
v_mfma_f32_32x32x16_bf16 v[128:143], v[36:39], v[44:47], v[128:143]
s_lshr_b64 s[24:25], s[4:5], 26
s_and_b32 s24, s24, 3
s_cmp_eq_u32 s24, 3
s_cbranch_scc1 stok_56
s_mov_b32 s26, 0
pl_57:
buffer_load_dword v11, v10, s[28:31], s23 offen sc1
s_waitcnt vmcnt(0)
v_cmp_eq_u32 s[4:5], s9, v11
s_add_u32 s26, s26, 1
s_nop 0
s_lshr_b64 s[24:25], s[4:5], 26
s_and_b32 s24, s24, 3
s_cmp_eq_u32 s24, 3
s_cbranch_scc1 plok_58
s_cmp_lt_u32 s26, 60000
s_cbranch_scc1 pl_57
plok_58:
stok_56:
buffer_load_dwordx4 v[32:35], v2, s[28:31], s17 offen offset:0 sc1
buffer_load_dwordx4 v[36:39], v2, s[28:31], s17 offen offset:512 sc1
buffer_load_dwordx4 v[40:43], v3, s[28:31], s16 offen offset:0 sc1
buffer_load_dwordx4 v[44:47], v3, s[28:31], s16 offen offset:512 sc1
s_add_u32 s17, s17, 176128
s_add_u32 s16, s16, 65536
s_waitcnt vmcnt(12)
v_mfma_f32_32x32x16_bf16 v[80:95], v[48:51], v[56:59], v[80:95]
v_mfma_f32_32x32x16_bf16 v[96:111], v[48:51], v[60:63], v[96:111]
v_mfma_f32_32x32x16_bf16 v[112:127], v[52:55], v[56:59], v[112:127]
v_mfma_f32_32x32x16_bf16 v[128:143], v[52:55], v[60:63], v[128:143]
s_lshr_b64 s[24:25], s[4:5], 28
s_and_b32 s24, s24, 3
s_cmp_eq_u32 s24, 3
s_cbranch_scc1 stok_59
s_mov_b32 s26, 0
pl_60:
buffer_load_dword v11, v10, s[28:31], s23 offen sc1
s_waitcnt vmcnt(0)
v_cmp_eq_u32 s[4:5], s9, v11
s_add_u32 s26, s26, 1
s_nop 0
s_lshr_b64 s[24:25], s[4:5], 28
s_and_b32 s24, s24, 3
s_cmp_eq_u32 s24, 3
s_cbranch_scc1 plok_61
s_cmp_lt_u32 s26, 60000
s_cbranch_scc1 pl_60
plok_61:
stok_59:
buffer_load_dwordx4 v[48:51], v2, s[28:31], s17 offen offset:0 sc1
buffer_load_dwordx4 v[52:55], v2, s[28:31], s17 offen offset:512 sc1
buffer_load_dwordx4 v[56:59], v3, s[28:31], s16 offen offset:0 sc1
buffer_load_dwordx4 v[60:63], v3, s[28:31], s16 offen offset:512 sc1
s_add_u32 s17, s17, 176128
s_add_u32 s16, s16, 65536
s_waitcnt vmcnt(12)
v_mfma_f32_32x32x16_bf16 v[80:95], v[64:67], v[72:75], v[80:95]
v_mfma_f32_32x32x16_bf16 v[96:111], v[64:67], v[76:79], v[96:111]
v_mfma_f32_32x32x16_bf16 v[112:127], v[68:71], v[72:75], v[112:127]
v_mfma_f32_32x32x16_bf16 v[128:143], v[68:71], v[76:79], v[128:143]
s_lshr_b64 s[24:25], s[4:5], 30
s_and_b32 s24, s24, 3
s_cmp_eq_u32 s24, 3
s_cbranch_scc1 stok_62
s_mov_b32 s26, 0
pl_63:
buffer_load_dword v11, v10, s[28:31], s23 offen sc1
s_waitcnt vmcnt(0)
v_cmp_eq_u32 s[4:5], s9, v11
s_add_u32 s26, s26, 1
s_nop 0
s_lshr_b64 s[24:25], s[4:5], 30
s_and_b32 s24, s24, 3
s_cmp_eq_u32 s24, 3
s_cbranch_scc1 plok_64
s_cmp_lt_u32 s26, 60000
s_cbranch_scc1 pl_63
plok_64:
stok_62:
buffer_load_dwordx4 v[64:67], v2, s[28:31], s17 offen offset:0 sc1
buffer_load_dwordx4 v[68:71], v2, s[28:31], s17 offen offset:512 sc1
buffer_load_dwordx4 v[72:75], v3, s[28:31], s16 offen offset:0 sc1
buffer_load_dwordx4 v[76:79], v3, s[28:31], s16 offen offset:512 sc1
s_add_u32 s17, s17, 176128
s_add_u32 s16, s16, 65536
s_waitcnt vmcnt(12)
v_mfma_f32_32x32x16_bf16 v[80:95], v[16:19], v[24:27], v[80:95]
v_mfma_f32_32x32x16_bf16 v[96:111], v[16:19], v[28:31], v[96:111]
v_mfma_f32_32x32x16_bf16 v[112:127], v[20:23], v[24:27], v[112:127]
v_mfma_f32_32x32x16_bf16 v[128:143], v[20:23], v[28:31], v[128:143]
s_lshr_b64 s[24:25], s[4:5], 32
s_and_b32 s24, s24, 3
s_cmp_eq_u32 s24, 3
s_cbranch_scc1 stok_65
s_mov_b32 s26, 0
pl_66:
buffer_load_dword v11, v10, s[28:31], s23 offen sc1
s_waitcnt vmcnt(0)
v_cmp_eq_u32 s[4:5], s9, v11
s_add_u32 s26, s26, 1
s_nop 0
s_lshr_b64 s[24:25], s[4:5], 32
s_and_b32 s24, s24, 3
s_cmp_eq_u32 s24, 3
s_cbranch_scc1 plok_67
s_cmp_lt_u32 s26, 60000
s_cbranch_scc1 pl_66
plok_67:
stok_65:
buffer_load_dwordx4 v[16:19], v2, s[28:31], s17 offen offset:0 sc1
buffer_load_dwordx4 v[20:23], v2, s[28:31], s17 offen offset:512 sc1
buffer_load_dwordx4 v[24:27], v3, s[28:31], s16 offen offset:0 sc1
buffer_load_dwordx4 v[28:31], v3, s[28:31], s16 offen offset:512 sc1
s_add_u32 s17, s17, 176128
s_add_u32 s16, s16, 65536
s_waitcnt vmcnt(12)
v_mfma_f32_32x32x16_bf16 v[80:95], v[32:35], v[40:43], v[80:95]
v_mfma_f32_32x32x16_bf16 v[96:111], v[32:35], v[44:47], v[96:111]
v_mfma_f32_32x32x16_bf16 v[112:127], v[36:39], v[40:43], v[112:127]
v_mfma_f32_32x32x16_bf16 v[128:143], v[36:39], v[44:47], v[128:143]
s_lshr_b64 s[24:25], s[4:5], 34
s_and_b32 s24, s24, 3
s_cmp_eq_u32 s24, 3
s_cbranch_scc1 stok_68
s_mov_b32 s26, 0
pl_69:
buffer_load_dword v11, v10, s[28:31], s23 offen sc1
s_waitcnt vmcnt(0)
v_cmp_eq_u32 s[4:5], s9, v11
s_add_u32 s26, s26, 1
s_nop 0
s_lshr_b64 s[24:25], s[4:5], 34
s_and_b32 s24, s24, 3
s_cmp_eq_u32 s24, 3
s_cbranch_scc1 plok_70
s_cmp_lt_u32 s26, 60000
s_cbranch_scc1 pl_69
plok_70:
stok_68:
buffer_load_dwordx4 v[32:35], v2, s[28:31], s17 offen offset:0 sc1
buffer_load_dwordx4 v[36:39], v2, s[28:31], s17 offen offset:512 sc1
buffer_load_dwordx4 v[40:43], v3, s[28:31], s16 offen offset:0 sc1
buffer_load_dwordx4 v[44:47], v3, s[28:31], s16 offen offset:512 sc1
s_add_u32 s17, s17, 176128
s_add_u32 s16, s16, 65536
s_waitcnt vmcnt(12)
v_mfma_f32_32x32x16_bf16 v[80:95], v[48:51], v[56:59], v[80:95]
v_mfma_f32_32x32x16_bf16 v[96:111], v[48:51], v[60:63], v[96:111]
v_mfma_f32_32x32x16_bf16 v[112:127], v[52:55], v[56:59], v[112:127]
v_mfma_f32_32x32x16_bf16 v[128:143], v[52:55], v[60:63], v[128:143]
s_lshr_b64 s[24:25], s[4:5], 36
s_and_b32 s24, s24, 3
s_cmp_eq_u32 s24, 3
s_cbranch_scc1 stok_71
s_mov_b32 s26, 0
pl_72:
buffer_load_dword v11, v10, s[28:31], s23 offen sc1
s_waitcnt vmcnt(0)
v_cmp_eq_u32 s[4:5], s9, v11
s_add_u32 s26, s26, 1
s_nop 0
s_lshr_b64 s[24:25], s[4:5], 36
s_and_b32 s24, s24, 3
s_cmp_eq_u32 s24, 3
s_cbranch_scc1 plok_73
s_cmp_lt_u32 s26, 60000
s_cbranch_scc1 pl_72
plok_73:
stok_71:
buffer_load_dwordx4 v[48:51], v2, s[28:31], s17 offen offset:0 sc1
buffer_load_dwordx4 v[52:55], v2, s[28:31], s17 offen offset:512 sc1
buffer_load_dwordx4 v[56:59], v3, s[28:31], s16 offen offset:0 sc1
buffer_load_dwordx4 v[60:63], v3, s[28:31], s16 offen offset:512 sc1
s_add_u32 s17, s17, 176128
s_add_u32 s16, s16, 65536
s_waitcnt vmcnt(12)
v_mfma_f32_32x32x16_bf16 v[80:95], v[64:67], v[72:75], v[80:95]
v_mfma_f32_32x32x16_bf16 v[96:111], v[64:67], v[76:79], v[96:111]
v_mfma_f32_32x32x16_bf16 v[112:127], v[68:71], v[72:75], v[112:127]
v_mfma_f32_32x32x16_bf16 v[128:143], v[68:71], v[76:79], v[128:143]
s_lshr_b64 s[24:25], s[4:5], 38
s_and_b32 s24, s24, 3
s_cmp_eq_u32 s24, 3
s_cbranch_scc1 stok_74
s_mov_b32 s26, 0
pl_75:
buffer_load_dword v11, v10, s[28:31], s23 offen sc1
s_waitcnt vmcnt(0)
v_cmp_eq_u32 s[4:5], s9, v11
s_add_u32 s26, s26, 1
s_nop 0
s_lshr_b64 s[24:25], s[4:5], 38
s_and_b32 s24, s24, 3
s_cmp_eq_u32 s24, 3
s_cbranch_scc1 plok_76
s_cmp_lt_u32 s26, 60000
s_cbranch_scc1 pl_75
plok_76:
stok_74:
buffer_load_dwordx4 v[64:67], v2, s[28:31], s17 offen offset:0 sc1
buffer_load_dwordx4 v[68:71], v2, s[28:31], s17 offen offset:512 sc1
buffer_load_dwordx4 v[72:75], v3, s[28:31], s16 offen offset:0 sc1
buffer_load_dwordx4 v[76:79], v3, s[28:31], s16 offen offset:512 sc1
s_add_u32 s17, s17, 176128
s_add_u32 s16, s16, 65536
s_waitcnt vmcnt(12)
v_mfma_f32_32x32x16_bf16 v[80:95], v[16:19], v[24:27], v[80:95]
v_mfma_f32_32x32x16_bf16 v[96:111], v[16:19], v[28:31], v[96:111]
v_mfma_f32_32x32x16_bf16 v[112:127], v[20:23], v[24:27], v[112:127]
v_mfma_f32_32x32x16_bf16 v[128:143], v[20:23], v[28:31], v[128:143]
s_lshr_b64 s[24:25], s[4:5], 40
s_and_b32 s24, s24, 3
s_cmp_eq_u32 s24, 3
s_cbranch_scc1 stok_77
s_mov_b32 s26, 0
pl_78:
buffer_load_dword v11, v10, s[28:31], s23 offen sc1
s_waitcnt vmcnt(0)
v_cmp_eq_u32 s[4:5], s9, v11
s_add_u32 s26, s26, 1
s_nop 0
s_lshr_b64 s[24:25], s[4:5], 40
s_and_b32 s24, s24, 3
s_cmp_eq_u32 s24, 3
s_cbranch_scc1 plok_79
s_cmp_lt_u32 s26, 60000
s_cbranch_scc1 pl_78
plok_79:
stok_77:
buffer_load_dwordx4 v[16:19], v2, s[28:31], s17 offen offset:0 sc1
buffer_load_dwordx4 v[20:23], v2, s[28:31], s17 offen offset:512 sc1
buffer_load_dwordx4 v[24:27], v3, s[28:31], s16 offen offset:0 sc1
buffer_load_dwordx4 v[28:31], v3, s[28:31], s16 offen offset:512 sc1
s_add_u32 s17, s17, 176128
s_add_u32 s16, s16, 65536
s_waitcnt vmcnt(12)
v_mfma_f32_32x32x16_bf16 v[80:95], v[32:35], v[40:43], v[80:95]
v_mfma_f32_32x32x16_bf16 v[96:111], v[32:35], v[44:47], v[96:111]
v_mfma_f32_32x32x16_bf16 v[112:127], v[36:39], v[40:43], v[112:127]
v_mfma_f32_32x32x16_bf16 v[128:143], v[36:39], v[44:47], v[128:143]
s_lshr_b64 s[24:25], s[4:5], 42
s_and_b32 s24, s24, 3
s_cmp_eq_u32 s24, 3
s_cbranch_scc1 stok_80
s_mov_b32 s26, 0
pl_81:
buffer_load_dword v11, v10, s[28:31], s23 offen sc1
s_waitcnt vmcnt(0)
v_cmp_eq_u32 s[4:5], s9, v11
s_add_u32 s26, s26, 1
s_nop 0
s_lshr_b64 s[24:25], s[4:5], 42
s_and_b32 s24, s24, 3
s_cmp_eq_u32 s24, 3
s_cbranch_scc1 plok_82
s_cmp_lt_u32 s26, 60000
s_cbranch_scc1 pl_81
plok_82:
stok_80:
buffer_load_dwordx4 v[32:35], v2, s[28:31], s17 offen offset:0 sc1
buffer_load_dwordx4 v[36:39], v2, s[28:31], s17 offen offset:512 sc1
buffer_load_dwordx4 v[40:43], v3, s[28:31], s16 offen offset:0 sc1
buffer_load_dwordx4 v[44:47], v3, s[28:31], s16 offen offset:512 sc1
s_add_u32 s17, s17, 176128
s_add_u32 s16, s16, 65536
s_waitcnt vmcnt(12)
v_mfma_f32_32x32x16_bf16 v[80:95], v[48:51], v[56:59], v[80:95]
v_mfma_f32_32x32x16_bf16 v[96:111], v[48:51], v[60:63], v[96:111]
v_mfma_f32_32x32x16_bf16 v[112:127], v[52:55], v[56:59], v[112:127]
v_mfma_f32_32x32x16_bf16 v[128:143], v[52:55], v[60:63], v[128:143]
s_lshr_b64 s[24:25], s[4:5], 44
s_and_b32 s24, s24, 3
s_cmp_eq_u32 s24, 3
s_cbranch_scc1 stok_83
s_mov_b32 s26, 0
pl_84:
buffer_load_dword v11, v10, s[28:31], s23 offen sc1
s_waitcnt vmcnt(0)
v_cmp_eq_u32 s[4:5], s9, v11
s_add_u32 s26, s26, 1
s_nop 0
s_lshr_b64 s[24:25], s[4:5], 44
s_and_b32 s24, s24, 3
s_cmp_eq_u32 s24, 3
s_cbranch_scc1 plok_85
s_cmp_lt_u32 s26, 60000
s_cbranch_scc1 pl_84
plok_85:
stok_83:
buffer_load_dwordx4 v[48:51], v2, s[28:31], s17 offen offset:0 sc1
buffer_load_dwordx4 v[52:55], v2, s[28:31], s17 offen offset:512 sc1
buffer_load_dwordx4 v[56:59], v3, s[28:31], s16 offen offset:0 sc1
buffer_load_dwordx4 v[60:63], v3, s[28:31], s16 offen offset:512 sc1
s_add_u32 s17, s17, 176128
s_add_u32 s16, s16, 65536
s_waitcnt vmcnt(12)
v_mfma_f32_32x32x16_bf16 v[80:95], v[64:67], v[72:75], v[80:95]
v_mfma_f32_32x32x16_bf16 v[96:111], v[64:67], v[76:79], v[96:111]
v_mfma_f32_32x32x16_bf16 v[112:127], v[68:71], v[72:75], v[112:127]
v_mfma_f32_32x32x16_bf16 v[128:143], v[68:71], v[76:79], v[128:143]
s_lshr_b64 s[24:25], s[4:5], 46
s_and_b32 s24, s24, 3
s_cmp_eq_u32 s24, 3
s_cbranch_scc1 stok_86
s_mov_b32 s26, 0
pl_87:
buffer_load_dword v11, v10, s[28:31], s23 offen sc1
s_waitcnt vmcnt(0)
v_cmp_eq_u32 s[4:5], s9, v11
s_add_u32 s26, s26, 1
s_nop 0
s_lshr_b64 s[24:25], s[4:5], 46
s_and_b32 s24, s24, 3
s_cmp_eq_u32 s24, 3
s_cbranch_scc1 plok_88
s_cmp_lt_u32 s26, 60000
s_cbranch_scc1 pl_87
plok_88:
stok_86:
buffer_load_dwordx4 v[64:67], v2, s[28:31], s17 offen offset:0 sc1
buffer_load_dwordx4 v[68:71], v2, s[28:31], s17 offen offset:512 sc1
buffer_load_dwordx4 v[72:75], v3, s[28:31], s16 offen offset:0 sc1
buffer_load_dwordx4 v[76:79], v3, s[28:31], s16 offen offset:512 sc1
s_add_u32 s17, s17, 176128
s_add_u32 s16, s16, 65536
s_waitcnt vmcnt(12)
v_mfma_f32_32x32x16_bf16 v[80:95], v[16:19], v[24:27], v[80:95]
v_mfma_f32_32x32x16_bf16 v[96:111], v[16:19], v[28:31], v[96:111]
v_mfma_f32_32x32x16_bf16 v[112:127], v[20:23], v[24:27], v[112:127]
v_mfma_f32_32x32x16_bf16 v[128:143], v[20:23], v[28:31], v[128:143]
s_lshr_b64 s[24:25], s[4:5], 48
s_and_b32 s24, s24, 3
s_cmp_eq_u32 s24, 3
s_cbranch_scc1 stok_89
s_mov_b32 s26, 0
pl_90:
buffer_load_dword v11, v10, s[28:31], s23 offen sc1
s_waitcnt vmcnt(0)
v_cmp_eq_u32 s[4:5], s9, v11
s_add_u32 s26, s26, 1
s_nop 0
s_lshr_b64 s[24:25], s[4:5], 48
s_and_b32 s24, s24, 3
s_cmp_eq_u32 s24, 3
s_cbranch_scc1 plok_91
s_cmp_lt_u32 s26, 60000
s_cbranch_scc1 pl_90
plok_91:
stok_89:
buffer_load_dwordx4 v[16:19], v2, s[28:31], s17 offen offset:0 sc1
buffer_load_dwordx4 v[20:23], v2, s[28:31], s17 offen offset:512 sc1
buffer_load_dwordx4 v[24:27], v3, s[28:31], s16 offen offset:0 sc1
buffer_load_dwordx4 v[28:31], v3, s[28:31], s16 offen offset:512 sc1
s_add_u32 s17, s17, 176128
s_add_u32 s16, s16, 65536
s_waitcnt vmcnt(12)
v_mfma_f32_32x32x16_bf16 v[80:95], v[32:35], v[40:43], v[80:95]
v_mfma_f32_32x32x16_bf16 v[96:111], v[32:35], v[44:47], v[96:111]
v_mfma_f32_32x32x16_bf16 v[112:127], v[36:39], v[40:43], v[112:127]
v_mfma_f32_32x32x16_bf16 v[128:143], v[36:39], v[44:47], v[128:143]
s_lshr_b64 s[24:25], s[4:5], 50
s_and_b32 s24, s24, 3
s_cmp_eq_u32 s24, 3
s_cbranch_scc1 stok_92
s_mov_b32 s26, 0
pl_93:
buffer_load_dword v11, v10, s[28:31], s23 offen sc1
s_waitcnt vmcnt(0)
v_cmp_eq_u32 s[4:5], s9, v11
s_add_u32 s26, s26, 1
s_nop 0
s_lshr_b64 s[24:25], s[4:5], 50
s_and_b32 s24, s24, 3
s_cmp_eq_u32 s24, 3
s_cbranch_scc1 plok_94
s_cmp_lt_u32 s26, 60000
s_cbranch_scc1 pl_93
plok_94:
stok_92:
buffer_load_dwordx4 v[32:35], v2, s[28:31], s17 offen offset:0 sc1
buffer_load_dwordx4 v[36:39], v2, s[28:31], s17 offen offset:512 sc1
buffer_load_dwordx4 v[40:43], v3, s[28:31], s16 offen offset:0 sc1
buffer_load_dwordx4 v[44:47], v3, s[28:31], s16 offen offset:512 sc1
s_add_u32 s17, s17, 176128
s_add_u32 s16, s16, 65536
s_waitcnt vmcnt(12)
v_mfma_f32_32x32x16_bf16 v[80:95], v[48:51], v[56:59], v[80:95]
v_mfma_f32_32x32x16_bf16 v[96:111], v[48:51], v[60:63], v[96:111]
v_mfma_f32_32x32x16_bf16 v[112:127], v[52:55], v[56:59], v[112:127]
v_mfma_f32_32x32x16_bf16 v[128:143], v[52:55], v[60:63], v[128:143]
s_lshr_b64 s[24:25], s[4:5], 52
s_and_b32 s24, s24, 3
s_cmp_eq_u32 s24, 3
s_cbranch_scc1 stok_95
s_mov_b32 s26, 0
pl_96:
buffer_load_dword v11, v10, s[28:31], s23 offen sc1
s_waitcnt vmcnt(0)
v_cmp_eq_u32 s[4:5], s9, v11
s_add_u32 s26, s26, 1
s_nop 0
s_lshr_b64 s[24:25], s[4:5], 52
s_and_b32 s24, s24, 3
s_cmp_eq_u32 s24, 3
s_cbranch_scc1 plok_97
s_cmp_lt_u32 s26, 60000
s_cbranch_scc1 pl_96
plok_97:
stok_95:
buffer_load_dwordx4 v[48:51], v2, s[28:31], s17 offen offset:0 sc1
buffer_load_dwordx4 v[52:55], v2, s[28:31], s17 offen offset:512 sc1
buffer_load_dwordx4 v[56:59], v3, s[28:31], s16 offen offset:0 sc1
buffer_load_dwordx4 v[60:63], v3, s[28:31], s16 offen offset:512 sc1
s_add_u32 s17, s17, 176128
s_add_u32 s16, s16, 65536
s_waitcnt vmcnt(12)
v_mfma_f32_32x32x16_bf16 v[80:95], v[64:67], v[72:75], v[80:95]
v_mfma_f32_32x32x16_bf16 v[96:111], v[64:67], v[76:79], v[96:111]
v_mfma_f32_32x32x16_bf16 v[112:127], v[68:71], v[72:75], v[112:127]
v_mfma_f32_32x32x16_bf16 v[128:143], v[68:71], v[76:79], v[128:143]
s_lshr_b64 s[24:25], s[4:5], 54
s_and_b32 s24, s24, 3
s_cmp_eq_u32 s24, 3
s_cbranch_scc1 stok_98
s_mov_b32 s26, 0
pl_99:
buffer_load_dword v11, v10, s[28:31], s23 offen sc1
s_waitcnt vmcnt(0)
v_cmp_eq_u32 s[4:5], s9, v11
s_add_u32 s26, s26, 1
s_nop 0
s_lshr_b64 s[24:25], s[4:5], 54
s_and_b32 s24, s24, 3
s_cmp_eq_u32 s24, 3
s_cbranch_scc1 plok_100
s_cmp_lt_u32 s26, 60000
s_cbranch_scc1 pl_99
plok_100:
stok_98:
buffer_load_dwordx4 v[64:67], v2, s[28:31], s17 offen offset:0 sc1
buffer_load_dwordx4 v[68:71], v2, s[28:31], s17 offen offset:512 sc1
buffer_load_dwordx4 v[72:75], v3, s[28:31], s16 offen offset:0 sc1
buffer_load_dwordx4 v[76:79], v3, s[28:31], s16 offen offset:512 sc1
s_add_u32 s17, s17, 176128
s_add_u32 s16, s16, 65536
s_waitcnt vmcnt(12)
v_mfma_f32_32x32x16_bf16 v[80:95], v[16:19], v[24:27], v[80:95]
v_mfma_f32_32x32x16_bf16 v[96:111], v[16:19], v[28:31], v[96:111]
v_mfma_f32_32x32x16_bf16 v[112:127], v[20:23], v[24:27], v[112:127]
v_mfma_f32_32x32x16_bf16 v[128:143], v[20:23], v[28:31], v[128:143]
s_lshr_b64 s[24:25], s[4:5], 56
s_and_b32 s24, s24, 3
s_cmp_eq_u32 s24, 3
s_cbranch_scc1 stok_101
s_mov_b32 s26, 0
pl_102:
buffer_load_dword v11, v10, s[28:31], s23 offen sc1
s_waitcnt vmcnt(0)
v_cmp_eq_u32 s[4:5], s9, v11
s_add_u32 s26, s26, 1
s_nop 0
s_lshr_b64 s[24:25], s[4:5], 56
s_and_b32 s24, s24, 3
s_cmp_eq_u32 s24, 3
s_cbranch_scc1 plok_103
s_cmp_lt_u32 s26, 60000
s_cbranch_scc1 pl_102
plok_103:
stok_101:
buffer_load_dwordx4 v[16:19], v2, s[28:31], s17 offen offset:0 sc1
buffer_load_dwordx4 v[20:23], v2, s[28:31], s17 offen offset:512 sc1
buffer_load_dwordx4 v[24:27], v3, s[28:31], s16 offen offset:0 sc1
buffer_load_dwordx4 v[28:31], v3, s[28:31], s16 offen offset:512 sc1
s_add_u32 s17, s17, 176128
s_add_u32 s16, s16, 65536
s_waitcnt vmcnt(12)
v_mfma_f32_32x32x16_bf16 v[80:95], v[32:35], v[40:43], v[80:95]
v_mfma_f32_32x32x16_bf16 v[96:111], v[32:35], v[44:47], v[96:111]
v_mfma_f32_32x32x16_bf16 v[112:127], v[36:39], v[40:43], v[112:127]
v_mfma_f32_32x32x16_bf16 v[128:143], v[36:39], v[44:47], v[128:143]
s_lshr_b64 s[24:25], s[4:5], 58
s_and_b32 s24, s24, 3
s_cmp_eq_u32 s24, 3
s_cbranch_scc1 stok_104
s_mov_b32 s26, 0
pl_105:
buffer_load_dword v11, v10, s[28:31], s23 offen sc1
s_waitcnt vmcnt(0)
v_cmp_eq_u32 s[4:5], s9, v11
s_add_u32 s26, s26, 1
s_nop 0
s_lshr_b64 s[24:25], s[4:5], 58
s_and_b32 s24, s24, 3
s_cmp_eq_u32 s24, 3
s_cbranch_scc1 plok_106
s_cmp_lt_u32 s26, 60000
s_cbranch_scc1 pl_105
plok_106:
stok_104:
buffer_load_dwordx4 v[32:35], v2, s[28:31], s17 offen offset:0 sc1
buffer_load_dwordx4 v[36:39], v2, s[28:31], s17 offen offset:512 sc1
buffer_load_dwordx4 v[40:43], v3, s[28:31], s16 offen offset:0 sc1
buffer_load_dwordx4 v[44:47], v3, s[28:31], s16 offen offset:512 sc1
s_add_u32 s17, s17, 176128
s_add_u32 s16, s16, 65536
s_waitcnt vmcnt(12)
v_mfma_f32_32x32x16_bf16 v[80:95], v[48:51], v[56:59], v[80:95]
v_mfma_f32_32x32x16_bf16 v[96:111], v[48:51], v[60:63], v[96:111]
v_mfma_f32_32x32x16_bf16 v[112:127], v[52:55], v[56:59], v[112:127]
v_mfma_f32_32x32x16_bf16 v[128:143], v[52:55], v[60:63], v[128:143]
s_lshr_b64 s[24:25], s[4:5], 60
s_and_b32 s24, s24, 3
s_cmp_eq_u32 s24, 3
s_cbranch_scc1 stok_107
s_mov_b32 s26, 0
pl_108:
buffer_load_dword v11, v10, s[28:31], s23 offen sc1
s_waitcnt vmcnt(0)
v_cmp_eq_u32 s[4:5], s9, v11
s_add_u32 s26, s26, 1
s_nop 0
s_lshr_b64 s[24:25], s[4:5], 60
s_and_b32 s24, s24, 3
s_cmp_eq_u32 s24, 3
s_cbranch_scc1 plok_109
s_cmp_lt_u32 s26, 60000
s_cbranch_scc1 pl_108
plok_109:
stok_107:
buffer_load_dwordx4 v[48:51], v2, s[28:31], s17 offen offset:0 sc1
buffer_load_dwordx4 v[52:55], v2, s[28:31], s17 offen offset:512 sc1
buffer_load_dwordx4 v[56:59], v3, s[28:31], s16 offen offset:0 sc1
buffer_load_dwordx4 v[60:63], v3, s[28:31], s16 offen offset:512 sc1
s_add_u32 s17, s17, 176128
s_add_u32 s16, s16, 65536
s_waitcnt vmcnt(12)
v_mfma_f32_32x32x16_bf16 v[80:95], v[64:67], v[72:75], v[80:95]
v_mfma_f32_32x32x16_bf16 v[96:111], v[64:67], v[76:79], v[96:111]
v_mfma_f32_32x32x16_bf16 v[112:127], v[68:71], v[72:75], v[112:127]
v_mfma_f32_32x32x16_bf16 v[128:143], v[68:71], v[76:79], v[128:143]
s_lshr_b64 s[24:25], s[4:5], 62
s_and_b32 s24, s24, 3
s_cmp_eq_u32 s24, 3
s_cbranch_scc1 stok_110
s_mov_b32 s26, 0
pl_111:
buffer_load_dword v11, v10, s[28:31], s23 offen sc1
s_waitcnt vmcnt(0)
v_cmp_eq_u32 s[4:5], s9, v11
s_add_u32 s26, s26, 1
s_nop 0
s_lshr_b64 s[24:25], s[4:5], 62
s_and_b32 s24, s24, 3
s_cmp_eq_u32 s24, 3
s_cbranch_scc1 plok_112
s_cmp_lt_u32 s26, 60000
s_cbranch_scc1 pl_111
plok_112:
stok_110:
buffer_load_dwordx4 v[64:67], v2, s[28:31], s17 offen offset:0 sc1
buffer_load_dwordx4 v[68:71], v2, s[28:31], s17 offen offset:512 sc1
buffer_load_dwordx4 v[72:75], v3, s[28:31], s16 offen offset:0 sc1
buffer_load_dwordx4 v[76:79], v3, s[28:31], s16 offen offset:512 sc1
s_add_u32 s17, s17, 176128
s_add_u32 s16, s16, 65536
s_waitcnt vmcnt(12)
v_mfma_f32_32x32x16_bf16 v[80:95], v[16:19], v[24:27], v[80:95]
v_mfma_f32_32x32x16_bf16 v[96:111], v[16:19], v[28:31], v[96:111]
v_mfma_f32_32x32x16_bf16 v[112:127], v[20:23], v[24:27], v[112:127]
v_mfma_f32_32x32x16_bf16 v[128:143], v[20:23], v[28:31], v[128:143]
s_waitcnt vmcnt(8)
v_mfma_f32_32x32x16_bf16 v[80:95], v[32:35], v[40:43], v[80:95]
v_mfma_f32_32x32x16_bf16 v[96:111], v[32:35], v[44:47], v[96:111]
v_mfma_f32_32x32x16_bf16 v[112:127], v[36:39], v[40:43], v[112:127]
v_mfma_f32_32x32x16_bf16 v[128:143], v[36:39], v[44:47], v[128:143]
s_waitcnt vmcnt(4)
v_mfma_f32_32x32x16_bf16 v[80:95], v[48:51], v[56:59], v[80:95]
v_mfma_f32_32x32x16_bf16 v[96:111], v[48:51], v[60:63], v[96:111]
v_mfma_f32_32x32x16_bf16 v[112:127], v[52:55], v[56:59], v[112:127]
v_mfma_f32_32x32x16_bf16 v[128:143], v[52:55], v[60:63], v[128:143]
s_waitcnt vmcnt(0)
v_mfma_f32_32x32x16_bf16 v[80:95], v[64:67], v[72:75], v[80:95]
v_mfma_f32_32x32x16_bf16 v[96:111], v[64:67], v[76:79], v[96:111]
v_mfma_f32_32x32x16_bf16 v[112:127], v[68:71], v[72:75], v[112:127]
v_mfma_f32_32x32x16_bf16 v[128:143], v[68:71], v[76:79], v[128:143]
s_barrier
s_cmp_eq_u32 s2, 0
s_cbranch_scc0 gated_mix__linear_kernel_hedgehog__mixer_token_mlp__prompt_kernel_nobump
s_cmp_eq_u32 s8, 0
s_cbranch_scc0 gated_mix__linear_kernel_hedgehog__mixer_token_mlp__prompt_kernel_nobump
s_mov_b32 s24, 0x1800000
v_mov_b32 v14, s9
v_mov_b32 v15, 0
s_mov_b64 exec, 1
buffer_store_dword v14, v15, s[28:31], s24 offen sc1
s_mov_b64 exec, -1
gated_mix__linear_kernel_hedgehog__mixer_token_mlp__prompt_kernel_nobump:
s_lshl_b32 s18, s8, 12
s_add_u32 s18, s18, 65536
v_add_u32 v9, s18, v5
s_nop 7
ds_write_b128 v9, v[80:83] offset:0
ds_write_b128 v9, v[84:87] offset:1024
ds_write_b128 v9, v[88:91] offset:2048
ds_write_b128 v9, v[92:95] offset:3072
ds_write_b128 v9, v[96:99] offset:16384
ds_write_b128 v9, v[100:103] offset:17408
ds_write_b128 v9, v[104:107] offset:18432
ds_write_b128 v9, v[108:111] offset:19456
ds_write_b128 v9, v[112:115] offset:32768
ds_write_b128 v9, v[116:119] offset:33792
ds_write_b128 v9, v[120:123] offset:34816
ds_write_b128 v9, v[124:127] offset:35840
ds_write_b128 v9, v[128:131] offset:49152
ds_write_b128 v9, v[132:135] offset:50176
ds_write_b128 v9, v[136:139] offset:51200
ds_write_b128 v9, v[140:143] offset:52224
s_lshl_b32 s18, s8, 14
s_add_u32 s18, s18, 65536
v_add_u32 v9, s18, v5
s_waitcnt lgkmcnt(0)
v_mov_b32 v14, 159872
v_mov_b32 v15, 1
s_mov_b64 exec, 1
ds_add_u32 v14, v15
s_mov_b64 exec, -1
v_mov_b32 v14, 159872
s_mov_b32 s25, 0
sw_113:
ds_read_b32 v15, v14
s_add_u32 s25, s25, 1
s_waitcnt lgkmcnt(0)
v_readfirstlane_b32 s24, v15
s_cmp_ge_u32 s24, 4
s_cbranch_scc1 swd_114
s_cmp_lt_u32 s25, 4000000
s_cbranch_scc1 sw_113
swd_114:
ds_read_b128 v[144:147], v9 offset:0
ds_read_b128 v[148:151], v9 offset:1024
ds_read_b128 v[152:155], v9 offset:2048
ds_read_b128 v[156:159], v9 offset:3072
ds_read_b128 v[160:163], v9 offset:4096
ds_read_b128 v[164:167], v9 offset:5120
ds_read_b128 v[168:171], v9 offset:6144
ds_read_b128 v[172:175], v9 offset:7168
ds_read_b128 v[176:179], v9 offset:8192
ds_read_b128 v[180:183], v9 offset:9216
ds_read_b128 v[184:187], v9 offset:10240
ds_read_b128 v[188:191], v9 offset:11264
s_waitcnt lgkmcnt(4)
v_pk_add_f32 v[144:145], v[144:145], v[160:161]
v_pk_add_f32 v[146:147], v[146:147], v[162:163]
v_pk_add_f32 v[148:149], v[148:149], v[164:165]
v_pk_add_f32 v[150:151], v[150:151], v[166:167]
v_pk_add_f32 v[152:153], v[152:153], v[168:169]
v_pk_add_f32 v[154:155], v[154:155], v[170:171]
v_pk_add_f32 v[156:157], v[156:157], v[172:173]
v_pk_add_f32 v[158:159], v[158:159], v[174:175]
ds_read_b128 v[160:163], v9 offset:12288
ds_read_b128 v[164:167], v9 offset:13312
ds_read_b128 v[168:171], v9 offset:14336
ds_read_b128 v[172:175], v9 offset:15360
s_waitcnt lgkmcnt(4)
v_pk_add_f32 v[144:145], v[144:145], v[176:177]
v_pk_add_f32 v[146:147], v[146:147], v[178:179]
v_pk_add_f32 v[148:149], v[148:149], v[180:181]
v_pk_add_f32 v[150:151], v[150:151], v[182:183]
v_pk_add_f32 v[152:153], v[152:153], v[184:185]
v_pk_add_f32 v[154:155], v[154:155], v[186:187]
v_pk_add_f32 v[156:157], v[156:157], v[188:189]
v_pk_add_f32 v[158:159], v[158:159], v[190:191]
s_waitcnt lgkmcnt(0)
v_mov_b32 v14, 159876
v_mov_b32 v15, 1
s_mov_b64 exec, 1
ds_add_u32 v14, v15
s_mov_b64 exec, -1
v_pk_add_f32 v[144:145], v[144:145], v[160:161]
v_pk_add_f32 v[146:147], v[146:147], v[162:163]
v_pk_add_f32 v[148:149], v[148:149], v[164:165]
v_pk_add_f32 v[150:151], v[150:151], v[166:167]
v_pk_add_f32 v[152:153], v[152:153], v[168:169]
v_pk_add_f32 v[154:155], v[154:155], v[170:171]
v_pk_add_f32 v[156:157], v[156:157], v[172:173]
v_pk_add_f32 v[158:159], v[158:159], v[174:175]
s_mov_b32 s16, 0xc0135761
s_mov_b32 s17, 0xbdd2d3e8
v_mov_b32 v15, s16
v_lshlrev_b32 v16, 16, v192
v_and_b32 v17, 0xffff0000, v192
v_lshlrev_b32 v18, 16, v193
v_and_b32 v19, 0xffff0000, v193
v_lshlrev_b32 v20, 16, v194
v_and_b32 v21, 0xffff0000, v194
v_lshlrev_b32 v22, 16, v195
v_and_b32 v23, 0xffff0000, v195
v_lshlrev_b32 v24, 16, v196
v_and_b32 v25, 0xffff0000, v196
v_lshlrev_b32 v26, 16, v197
v_and_b32 v27, 0xffff0000, v197
v_lshlrev_b32 v28, 16, v198
v_and_b32 v29, 0xffff0000, v198
v_lshlrev_b32 v30, 16, v199
v_and_b32 v31, 0xffff0000, v199
v_pk_add_f32 v[144:145], v[144:145], v[16:17]
v_pk_add_f32 v[146:147], v[146:147], v[18:19]
v_pk_add_f32 v[148:149], v[148:149], v[20:21]
v_pk_add_f32 v[150:151], v[150:151], v[22:23]
v_pk_add_f32 v[152:153], v[152:153], v[24:25]
v_pk_add_f32 v[154:155], v[154:155], v[26:27]
v_pk_add_f32 v[156:157], v[156:157], v[28:29]
v_pk_add_f32 v[158:159], v[158:159], v[30:31]
v_pk_mul_f32 v[16:17], v[144:145], v[144:145]
v_pk_mul_f32 v[18:19], v[146:147], v[146:147]
v_pk_mul_f32 v[20:21], v[148:149], v[148:149]
v_pk_mul_f32 v[22:23], v[150:151], v[150:151]
v_pk_mul_f32 v[24:25], v[152:153], v[152:153]
v_pk_mul_f32 v[26:27], v[154:155], v[154:155]
v_pk_mul_f32 v[28:29], v[156:157], v[156:157]
v_pk_mul_f32 v[30:31], v[158:159], v[158:159]
v_fma_f32 v16, v16, s17, v15
v_fma_f32 v17, v17, s17, v15
v_fma_f32 v18, v18, s17, v15
v_fma_f32 v19, v19, s17, v15
v_fma_f32 v20, v20, s17, v15
v_fma_f32 v21, v21, s17, v15
v_fma_f32 v22, v22, s17, v15
v_fma_f32 v23, v23, s17, v15
v_fma_f32 v24, v24, s17, v15
v_fma_f32 v25, v25, s17, v15
v_fma_f32 v26, v26, s17, v15
v_fma_f32 v27, v27, s17, v15
v_fma_f32 v28, v28, s17, v15
v_fma_f32 v29, v29, s17, v15
v_fma_f32 v30, v30, s17, v15
v_fma_f32 v31, v31, s17, v15
v_pk_mul_f32 v[16:17], v[16:17], v[144:145]
v_pk_mul_f32 v[18:19], v[18:19], v[146:147]
v_pk_mul_f32 v[20:21], v[20:21], v[148:149]
v_pk_mul_f32 v[22:23], v[22:23], v[150:151]
v_pk_mul_f32 v[24:25], v[24:25], v[152:153]
v_pk_mul_f32 v[26:27], v[26:27], v[154:155]
v_pk_mul_f32 v[28:29], v[28:29], v[156:157]
v_pk_mul_f32 v[30:31], v[30:31], v[158:159]
v_exp_f32 v16, v16
v_exp_f32 v17, v17
v_exp_f32 v18, v18
v_exp_f32 v19, v19
v_exp_f32 v20, v20
v_exp_f32 v21, v21
v_exp_f32 v22, v22
v_exp_f32 v23, v23
v_exp_f32 v24, v24
v_exp_f32 v25, v25
v_exp_f32 v26, v26
v_exp_f32 v27, v27
v_exp_f32 v28, v28
v_exp_f32 v29, v29
v_exp_f32 v30, v30
v_exp_f32 v31, v31
v_add_f32 v16, 1.0, v16
v_add_f32 v17, 1.0, v17
v_add_f32 v18, 1.0, v18
v_add_f32 v19, 1.0, v19
v_add_f32 v20, 1.0, v20
v_add_f32 v21, 1.0, v21
v_add_f32 v22, 1.0, v22
v_add_f32 v23, 1.0, v23
v_add_f32 v24, 1.0, v24
v_add_f32 v25, 1.0, v25
v_add_f32 v26, 1.0, v26
v_add_f32 v27, 1.0, v27
v_add_f32 v28, 1.0, v28
v_add_f32 v29, 1.0, v29
v_add_f32 v30, 1.0, v30
v_add_f32 v31, 1.0, v31
v_rcp_f32 v16, v16
v_rcp_f32 v17, v17
v_rcp_f32 v18, v18
v_rcp_f32 v19, v19
v_rcp_f32 v20, v20
v_rcp_f32 v21, v21
v_rcp_f32 v22, v22
v_rcp_f32 v23, v23
v_rcp_f32 v24, v24
v_rcp_f32 v25, v25
v_rcp_f32 v26, v26
v_rcp_f32 v27, v27
v_rcp_f32 v28, v28
v_rcp_f32 v29, v29
v_rcp_f32 v30, v30
v_rcp_f32 v31, v31
s_nop 0
v_pk_mul_f32 v[144:145], v[144:145], v[16:17]
v_pk_mul_f32 v[146:147], v[146:147], v[18:19]
v_pk_mul_f32 v[148:149], v[148:149], v[20:21]
v_pk_mul_f32 v[150:151], v[150:151], v[22:23]
v_pk_mul_f32 v[152:153], v[152:153], v[24:25]
v_pk_mul_f32 v[154:155], v[154:155], v[26:27]
v_pk_mul_f32 v[156:157], v[156:157], v[28:29]
v_pk_mul_f32 v[158:159], v[158:159], v[30:31]
v_cvt_pk_bf16_f32 v32, v144, v145
v_cvt_pk_bf16_f32 v33, v146, v147
v_cvt_pk_bf16_f32 v34, v148, v149
v_cvt_pk_bf16_f32 v35, v150, v151
v_cvt_pk_bf16_f32 v36, v152, v153
v_cvt_pk_bf16_f32 v37, v154, v155
v_cvt_pk_bf16_f32 v38, v156, v157
v_cvt_pk_bf16_f32 v39, v158, v159
s_nop 1
v_permlane32_swap_b32 v32, v34
v_permlane32_swap_b32 v33, v35
v_permlane32_swap_b32 v36, v38
v_permlane32_swap_b32 v37, v39
s_mov_b32 s18, 16384
s_nop 0
buffer_store_dwordx4 v[32:35], v200, s[44:47], 0 offen sc1
buffer_store_dwordx4 v[36:39], v200, s[44:47], s18 offen sc1
v_mov_b32 v14, 159876
s_mov_b32 s25, 0
sw_115:
ds_read_b32 v15, v14
s_add_u32 s25, s25, 1
s_waitcnt lgkmcnt(0)
v_readfirstlane_b32 s24, v15
s_cmp_ge_u32 s24, 4
s_cbranch_scc1 swd_116
s_cmp_lt_u32 s25, 4000000
s_cbranch_scc1 sw_115
swd_116:
s_branch gated_mix__linear_kernel_hedgehog__mixer_token_mlp__prompt_kernel_noB1
gated_mix__linear_kernel_hedgehog__mixer_token_mlp__prompt_kernel_spare:
v_lshlrev_b32 v7, 6, v0
s_add_u32 s24, s23, 0
buffer_load_dword v18, v7, s[28:31], s24 offen sc1
s_add_u32 s24, s23, 4096
buffer_load_dword v19, v7, s[28:31], s24 offen sc1
s_add_u32 s24, s23, 8192
buffer_load_dword v20, v7, s[28:31], s24 offen sc1
s_add_u32 s24, s23, 12288
buffer_load_dword v21, v7, s[28:31], s24 offen sc1
s_lshr_b32 s17, s6, 1
s_mul_i32 s17, s17, 22
s_lshr_b32 s17, s17, 2
s_lshl_b32 s17, s17, 10
s_add_u32 s17, s17, 0x200000
s_and_b32 s27, s6, 1
s_lshl_b32 s27, s27, 12
s_add_u32 s27, s27, 0x0
s_sub_u32 s16, s7, 22
s_lshl_b32 s16, s16, 2
s_add_u32 s16, s16, s8
s_waitcnt vmcnt(0)
v_cmp_eq_u32 s[32:33], s9, v18
v_cmp_eq_u32 s[34:35], s9, v19
v_cmp_eq_u32 s[36:37], s9, v20
v_cmp_eq_u32 s[38:39], s9, v21
s_nop 1
s_cmp_eq_u32 s32, -1
s_cbranch_scc1 wok_119
s_mov_b32 s26, 0
wpl_120:
s_add_u32 s24, s23, 0
buffer_load_dword v18, v7, s[28:31], s24 offen sc1
s_waitcnt vmcnt(0)
v_cmp_eq_u32 s[32:33], s9, v18
s_add_u32 s26, s26, 1
s_nop 0
s_cmp_eq_u32 s32, -1
s_cbranch_scc1 wok_119
s_cmp_lt_u32 s26, 60000
s_cbranch_scc1 wpl_120
wok_119:
s_add_u32 s18, s16, 0
s_mul_i32 s24, s18, 6554
s_lshr_b32 s24, s24, 16
s_mul_i32 s25, s24, 10
s_sub_u32 s25, s18, s25
s_cmp_ge_u32 s25, 6
s_cbranch_scc1 p2h_117
s_lshl_b32 s25, s25, 6
v_add_u32 v9, s25, v0
v_mul_u32_u24 v12, 1366, v9
v_lshrrev_b32 v12, 16, v12
v_mul_u32_u24 v13, 48, v12
v_sub_u32 v13, v9, v13
v_mul_u32_u24 v12, 22016, v12
v_lshl_add_u32 v12, v13, 7, v12
s_mul_i32 s25, s24, 176128
s_add_u32 s25, s25, s17
buffer_load_dword v16, v12, s[28:31], s25 offen sc1
s_branch p2e_118
p2h_117:
s_sub_u32 s25, s25, 6
s_lshl_b32 s25, s25, 6
v_add_u32 v9, s25, v0
v_lshrrev_b32 v12, 5, v9
v_and_b32 v13, 31, v9
v_lshlrev_b32 v12, 13, v12
v_lshl_add_u32 v12, v13, 7, v12
s_lshl_b32 s25, s24, 16
s_add_u32 s25, s25, s27
buffer_load_dword v16, v12, s[28:31], s25 offen sc1
p2e_118:
s_cmp_eq_u32 s33, -1
s_cbranch_scc1 wok_123
s_mov_b32 s26, 0
wpl_124:
s_add_u32 s24, s23, 0
buffer_load_dword v18, v7, s[28:31], s24 offen sc1
s_waitcnt vmcnt(0)
v_cmp_eq_u32 s[32:33], s9, v18
s_add_u32 s26, s26, 1
s_nop 0
s_cmp_eq_u32 s33, -1
s_cbranch_scc1 wok_123
s_cmp_lt_u32 s26, 60000
s_cbranch_scc1 wpl_124
wok_123:
s_add_u32 s18, s16, 40
s_mul_i32 s24, s18, 6554
s_lshr_b32 s24, s24, 16
s_mul_i32 s25, s24, 10
s_sub_u32 s25, s18, s25
s_cmp_ge_u32 s25, 6
s_cbranch_scc1 p2h_121
s_lshl_b32 s25, s25, 6
v_add_u32 v9, s25, v0
v_mul_u32_u24 v12, 1366, v9
v_lshrrev_b32 v12, 16, v12
v_mul_u32_u24 v13, 48, v12
v_sub_u32 v13, v9, v13
v_mul_u32_u24 v12, 22016, v12
v_lshl_add_u32 v12, v13, 7, v12
s_mul_i32 s25, s24, 176128
s_add_u32 s25, s25, s17
buffer_load_dword v16, v12, s[28:31], s25 offen sc1
s_branch p2e_122
p2h_121:
s_sub_u32 s25, s25, 6
s_lshl_b32 s25, s25, 6
v_add_u32 v9, s25, v0
v_lshrrev_b32 v12, 5, v9
v_and_b32 v13, 31, v9
v_lshlrev_b32 v12, 13, v12
v_lshl_add_u32 v12, v13, 7, v12
s_lshl_b32 s25, s24, 16
s_add_u32 s25, s25, s27
buffer_load_dword v16, v12, s[28:31], s25 offen sc1
p2e_122:
s_cmp_eq_u32 s34, -1
s_cbranch_scc1 wok_127
s_mov_b32 s26, 0
wpl_128:
s_add_u32 s24, s23, 4096
buffer_load_dword v19, v7, s[28:31], s24 offen sc1
s_waitcnt vmcnt(0)
v_cmp_eq_u32 s[34:35], s9, v19
s_add_u32 s26, s26, 1
s_nop 0
s_cmp_eq_u32 s34, -1
s_cbranch_scc1 wok_127
s_cmp_lt_u32 s26, 60000
s_cbranch_scc1 wpl_128
wok_127:
s_add_u32 s18, s16, 80
s_mul_i32 s24, s18, 6554
s_lshr_b32 s24, s24, 16
s_mul_i32 s25, s24, 10
s_sub_u32 s25, s18, s25
s_cmp_ge_u32 s25, 6
s_cbranch_scc1 p2h_125
s_lshl_b32 s25, s25, 6
v_add_u32 v9, s25, v0
v_mul_u32_u24 v12, 1366, v9
v_lshrrev_b32 v12, 16, v12
v_mul_u32_u24 v13, 48, v12
v_sub_u32 v13, v9, v13
v_mul_u32_u24 v12, 22016, v12
v_lshl_add_u32 v12, v13, 7, v12
s_mul_i32 s25, s24, 176128
s_add_u32 s25, s25, s17
buffer_load_dword v16, v12, s[28:31], s25 offen sc1
s_branch p2e_126
p2h_125:
s_sub_u32 s25, s25, 6
s_lshl_b32 s25, s25, 6
v_add_u32 v9, s25, v0
v_lshrrev_b32 v12, 5, v9
v_and_b32 v13, 31, v9
v_lshlrev_b32 v12, 13, v12
v_lshl_add_u32 v12, v13, 7, v12
s_lshl_b32 s25, s24, 16
s_add_u32 s25, s25, s27
buffer_load_dword v16, v12, s[28:31], s25 offen sc1
p2e_126:
s_cmp_eq_u32 s35, -1
s_cbranch_scc1 wok_131
s_mov_b32 s26, 0
wpl_132:
s_add_u32 s24, s23, 4096
buffer_load_dword v19, v7, s[28:31], s24 offen sc1
s_waitcnt vmcnt(0)
v_cmp_eq_u32 s[34:35], s9, v19
s_add_u32 s26, s26, 1
s_nop 0
s_cmp_eq_u32 s35, -1
s_cbranch_scc1 wok_131
s_cmp_lt_u32 s26, 60000
s_cbranch_scc1 wpl_132
wok_131:
s_add_u32 s18, s16, 120
s_mul_i32 s24, s18, 6554
s_lshr_b32 s24, s24, 16
s_mul_i32 s25, s24, 10
s_sub_u32 s25, s18, s25
s_cmp_ge_u32 s25, 6
s_cbranch_scc1 p2h_129
s_lshl_b32 s25, s25, 6
v_add_u32 v9, s25, v0
v_mul_u32_u24 v12, 1366, v9
v_lshrrev_b32 v12, 16, v12
v_mul_u32_u24 v13, 48, v12
v_sub_u32 v13, v9, v13
v_mul_u32_u24 v12, 22016, v12
v_lshl_add_u32 v12, v13, 7, v12
s_mul_i32 s25, s24, 176128
s_add_u32 s25, s25, s17
buffer_load_dword v16, v12, s[28:31], s25 offen sc1
s_branch p2e_130
p2h_129:
s_sub_u32 s25, s25, 6
s_lshl_b32 s25, s25, 6
v_add_u32 v9, s25, v0
v_lshrrev_b32 v12, 5, v9
v_and_b32 v13, 31, v9
v_lshlrev_b32 v12, 13, v12
v_lshl_add_u32 v12, v13, 7, v12
s_lshl_b32 s25, s24, 16
s_add_u32 s25, s25, s27
buffer_load_dword v16, v12, s[28:31], s25 offen sc1
p2e_130:
s_cmp_eq_u32 s36, -1
s_cbranch_scc1 wok_135
s_mov_b32 s26, 0
wpl_136:
s_add_u32 s24, s23, 8192
buffer_load_dword v20, v7, s[28:31], s24 offen sc1
s_waitcnt vmcnt(0)
v_cmp_eq_u32 s[36:37], s9, v20
s_add_u32 s26, s26, 1
s_nop 0
s_cmp_eq_u32 s36, -1
s_cbranch_scc1 wok_135
s_cmp_lt_u32 s26, 60000
s_cbranch_scc1 wpl_136
wok_135:
s_add_u32 s18, s16, 160
s_mul_i32 s24, s18, 6554
s_lshr_b32 s24, s24, 16
s_mul_i32 s25, s24, 10
s_sub_u32 s25, s18, s25
s_cmp_ge_u32 s25, 6
s_cbranch_scc1 p2h_133
s_lshl_b32 s25, s25, 6
v_add_u32 v9, s25, v0
v_mul_u32_u24 v12, 1366, v9
v_lshrrev_b32 v12, 16, v12
v_mul_u32_u24 v13, 48, v12
v_sub_u32 v13, v9, v13
v_mul_u32_u24 v12, 22016, v12
v_lshl_add_u32 v12, v13, 7, v12
s_mul_i32 s25, s24, 176128
s_add_u32 s25, s25, s17
buffer_load_dword v16, v12, s[28:31], s25 offen sc1
s_branch p2e_134
p2h_133:
s_sub_u32 s25, s25, 6
s_lshl_b32 s25, s25, 6
v_add_u32 v9, s25, v0
v_lshrrev_b32 v12, 5, v9
v_and_b32 v13, 31, v9
v_lshlrev_b32 v12, 13, v12
v_lshl_add_u32 v12, v13, 7, v12
s_lshl_b32 s25, s24, 16
s_add_u32 s25, s25, s27
buffer_load_dword v16, v12, s[28:31], s25 offen sc1
p2e_134:
s_cmp_eq_u32 s37, -1
s_cbranch_scc1 wok_139
s_mov_b32 s26, 0
wpl_140:
s_add_u32 s24, s23, 8192
buffer_load_dword v20, v7, s[28:31], s24 offen sc1
s_waitcnt vmcnt(0)
v_cmp_eq_u32 s[36:37], s9, v20
s_add_u32 s26, s26, 1
s_nop 0
s_cmp_eq_u32 s37, -1
s_cbranch_scc1 wok_139
s_cmp_lt_u32 s26, 60000
s_cbranch_scc1 wpl_140
wok_139:
s_add_u32 s18, s16, 200
s_mul_i32 s24, s18, 6554
s_lshr_b32 s24, s24, 16
s_mul_i32 s25, s24, 10
s_sub_u32 s25, s18, s25
s_cmp_ge_u32 s25, 6
s_cbranch_scc1 p2h_137
s_lshl_b32 s25, s25, 6
v_add_u32 v9, s25, v0
v_mul_u32_u24 v12, 1366, v9
v_lshrrev_b32 v12, 16, v12
v_mul_u32_u24 v13, 48, v12
v_sub_u32 v13, v9, v13
v_mul_u32_u24 v12, 22016, v12
v_lshl_add_u32 v12, v13, 7, v12
s_mul_i32 s25, s24, 176128
s_add_u32 s25, s25, s17
buffer_load_dword v16, v12, s[28:31], s25 offen sc1
s_branch p2e_138
p2h_137:
s_sub_u32 s25, s25, 6
s_lshl_b32 s25, s25, 6
v_add_u32 v9, s25, v0
v_lshrrev_b32 v12, 5, v9
v_and_b32 v13, 31, v9
v_lshlrev_b32 v12, 13, v12
v_lshl_add_u32 v12, v13, 7, v12
s_lshl_b32 s25, s24, 16
s_add_u32 s25, s25, s27
buffer_load_dword v16, v12, s[28:31], s25 offen sc1
p2e_138:
s_cmp_eq_u32 s38, -1
s_cbranch_scc1 wok_143
s_mov_b32 s26, 0
wpl_144:
s_add_u32 s24, s23, 12288
buffer_load_dword v21, v7, s[28:31], s24 offen sc1
s_waitcnt vmcnt(0)
v_cmp_eq_u32 s[38:39], s9, v21
s_add_u32 s26, s26, 1
s_nop 0
s_cmp_eq_u32 s38, -1
s_cbranch_scc1 wok_143
s_cmp_lt_u32 s26, 60000
s_cbranch_scc1 wpl_144
wok_143:
s_add_u32 s18, s16, 240
s_mul_i32 s24, s18, 6554
s_lshr_b32 s24, s24, 16
s_mul_i32 s25, s24, 10
s_sub_u32 s25, s18, s25
s_cmp_ge_u32 s25, 6
s_cbranch_scc1 p2h_141
s_lshl_b32 s25, s25, 6
v_add_u32 v9, s25, v0
v_mul_u32_u24 v12, 1366, v9
v_lshrrev_b32 v12, 16, v12
v_mul_u32_u24 v13, 48, v12
v_sub_u32 v13, v9, v13
v_mul_u32_u24 v12, 22016, v12
v_lshl_add_u32 v12, v13, 7, v12
s_mul_i32 s25, s24, 176128
s_add_u32 s25, s25, s17
buffer_load_dword v16, v12, s[28:31], s25 offen sc1
s_branch p2e_142
p2h_141:
s_sub_u32 s25, s25, 6
s_lshl_b32 s25, s25, 6
v_add_u32 v9, s25, v0
v_lshrrev_b32 v12, 5, v9
v_and_b32 v13, 31, v9
v_lshlrev_b32 v12, 13, v12
v_lshl_add_u32 v12, v13, 7, v12
s_lshl_b32 s25, s24, 16
s_add_u32 s25, s25, s27
buffer_load_dword v16, v12, s[28:31], s25 offen sc1
p2e_142:
s_cmp_eq_u32 s39, -1
s_cbranch_scc1 wok_147
s_mov_b32 s26, 0
wpl_148:
s_add_u32 s24, s23, 12288
buffer_load_dword v21, v7, s[28:31], s24 offen sc1
s_waitcnt vmcnt(0)
v_cmp_eq_u32 s[38:39], s9, v21
s_add_u32 s26, s26, 1
s_nop 0
s_cmp_eq_u32 s39, -1
s_cbranch_scc1 wok_147
s_cmp_lt_u32 s26, 60000
s_cbranch_scc1 wpl_148
wok_147:
s_add_u32 s18, s16, 280
s_mul_i32 s24, s18, 6554
s_lshr_b32 s24, s24, 16
s_mul_i32 s25, s24, 10
s_sub_u32 s25, s18, s25
s_cmp_ge_u32 s25, 6
s_cbranch_scc1 p2h_145
s_lshl_b32 s25, s25, 6
v_add_u32 v9, s25, v0
v_mul_u32_u24 v12, 1366, v9
v_lshrrev_b32 v12, 16, v12
v_mul_u32_u24 v13, 48, v12
v_sub_u32 v13, v9, v13
v_mul_u32_u24 v12, 22016, v12
v_lshl_add_u32 v12, v13, 7, v12
s_mul_i32 s25, s24, 176128
s_add_u32 s25, s25, s17
buffer_load_dword v16, v12, s[28:31], s25 offen sc1
s_branch p2e_146
p2h_145:
s_sub_u32 s25, s25, 6
s_lshl_b32 s25, s25, 6
v_add_u32 v9, s25, v0
v_lshrrev_b32 v12, 5, v9
v_and_b32 v13, 31, v9
v_lshlrev_b32 v12, 13, v12
v_lshl_add_u32 v12, v13, 7, v12
s_lshl_b32 s25, s24, 16
s_add_u32 s25, s25, s27
buffer_load_dword v16, v12, s[28:31], s25 offen sc1
p2e_146:
s_barrier
s_cmp_ge_u32 s7, 26
s_cbranch_scc1 gated_mix__linear_kernel_hedgehog__mixer_token_mlp__prompt_kernel_toucher
s_sub_u32 s21, s7, 22
s_lshl_b32 s21, s21, 3
s_add_u32 s21, s21, s6
v_and_b32 v10, 31, v0
v_lshlrev_b32 v10, 6, v10
s_lshr_b32 s23, s21, 2
s_lshl_b32 s23, s23, 11
s_add_u32 s23, s23, 0x1808000
s_mov_b32 s26, 0
pl_149:
buffer_load_dword v11, v10, s[28:31], s23 offen sc1
s_waitcnt vmcnt(0)
v_cmp_eq_u32 s[4:5], s9, v11
s_add_u32 s26, s26, 1
s_nop 0
s_cmp_eq_u64 s[4:5], exec
s_cbranch_scc1 plok_150
s_cmp_lt_u32 s26, 60000
s_cbranch_scc1 pl_149
plok_150:
v_and_b32 v8, 31, v0
v_lshrrev_b32 v9, 5, v0
v_min_u32 v8, 16, v8
v_mul_u32_u24 v9, 17, v9
v_add_u32 v8, v8, v9
v_lshlrev_b32 v8, 4, v8
s_lshl_b32 s16, s8, 8
s_add_u32 s16, s16, s21
s_mul_i32 s16, s16, 2176
s_add_u32 s16, s16, 0xc00000
buffer_load_dwordx4 v[16:19], v8, s[28:31], s16 offen offset:0 sc1
buffer_load_dwordx4 v[20:23], v8, s[28:31], s16 offen offset:544 sc1
buffer_load_dwordx4 v[24:27], v8, s[28:31], s16 offen offset:1088 sc1
buffer_load_dwordx4 v[28:31], v8, s[28:31], s16 offen offset:1632 sc1
s_add_u32 s16, s16, 69632
buffer_load_dwordx4 v[32:35], v8, s[28:31], s16 offen offset:0 sc1
buffer_load_dwordx4 v[36:39], v8, s[28:31], s16 offen offset:544 sc1
buffer_load_dwordx4 v[40:43], v8, s[28:31], s16 offen offset:1088 sc1
buffer_load_dwordx4 v[44:47], v8, s[28:31], s16 offen offset:1632 sc1
s_add_u32 s16, s16, 69632
buffer_load_dwordx4 v[48:51], v8, s[28:31], s16 offen offset:0 sc1
buffer_load_dwordx4 v[52:55], v8, s[28:31], s16 offen offset:544 sc1
buffer_load_dwordx4 v[56:59], v8, s[28:31], s16 offen offset:1088 sc1
buffer_load_dwordx4 v[60:63], v8, s[28:31], s16 offen offset:1632 sc1
s_add_u32 s16, s16, 69632
buffer_load_dwordx4 v[64:67], v8, s[28:31], s16 offen offset:0 sc1
buffer_load_dwordx4 v[68:71], v8, s[28:31], s16 offen offset:544 sc1
buffer_load_dwordx4 v[72:75], v8, s[28:31], s16 offen offset:1088 sc1
buffer_load_dwordx4 v[76:79], v8, s[28:31], s16 offen offset:1632 sc1
s_add_u32 s16, s16, 69632
buffer_load_dwordx4 v[80:83], v8, s[28:31], s16 offen offset:0 sc1
buffer_load_dwordx4 v[84:87], v8, s[28:31], s16 offen offset:544 sc1
buffer_load_dwordx4 v[88:91], v8, s[28:31], s16 offen offset:1088 sc1
buffer_load_dwordx4 v[92:95], v8, s[28:31], s16 offen offset:1632 sc1
s_add_u32 s16, s16, 69632
buffer_load_dwordx4 v[96:99], v8, s[28:31], s16 offen offset:0 sc1
buffer_load_dwordx4 v[100:103], v8, s[28:31], s16 offen offset:544 sc1
buffer_load_dwordx4 v[104:107], v8, s[28:31], s16 offen offset:1088 sc1
buffer_load_dwordx4 v[108:111], v8, s[28:31], s16 offen offset:1632 sc1
s_add_u32 s16, s16, 69632
buffer_load_dwordx4 v[112:115], v8, s[28:31], s16 offen offset:0 sc1
buffer_load_dwordx4 v[116:119], v8, s[28:31], s16 offen offset:544 sc1
buffer_load_dwordx4 v[120:123], v8, s[28:31], s16 offen offset:1088 sc1
buffer_load_dwordx4 v[124:127], v8, s[28:31], s16 offen offset:1632 sc1
s_add_u32 s16, s16, 69632
buffer_load_dwordx4 v[128:131], v8, s[28:31], s16 offen offset:0 sc1
buffer_load_dwordx4 v[132:135], v8, s[28:31], s16 offen offset:544 sc1
buffer_load_dwordx4 v[136:139], v8, s[28:31], s16 offen offset:1088 sc1
buffer_load_dwordx4 v[140:143], v8, s[28:31], s16 offen offset:1632 sc1
s_waitcnt vmcnt(24)
v_pk_add_f32 v[144:145], v[16:17], v[32:33]
v_pk_add_f32 v[146:147], v[18:19], v[34:35]
v_pk_add_f32 v[148:149], v[20:21], v[36:37]
v_pk_add_f32 v[150:151], v[22:23], v[38:39]
v_pk_add_f32 v[152:153], v[24:25], v[40:41]
v_pk_add_f32 v[154:155], v[26:27], v[42:43]
v_pk_add_f32 v[156:157], v[28:29], v[44:45]
v_pk_add_f32 v[158:159], v[30:31], v[46:47]
s_waitcnt vmcnt(20)
v_pk_add_f32 v[144:145], v[144:145], v[48:49]
v_pk_add_f32 v[146:147], v[146:147], v[50:51]
v_pk_add_f32 v[148:149], v[148:149], v[52:53]
v_pk_add_f32 v[150:151], v[150:151], v[54:55]
v_pk_add_f32 v[152:153], v[152:153], v[56:57]
v_pk_add_f32 v[154:155], v[154:155], v[58:59]
v_pk_add_f32 v[156:157], v[156:157], v[60:61]
v_pk_add_f32 v[158:159], v[158:159], v[62:63]
s_waitcnt vmcnt(16)
v_pk_add_f32 v[144:145], v[144:145], v[64:65]
v_pk_add_f32 v[146:147], v[146:147], v[66:67]
v_pk_add_f32 v[148:149], v[148:149], v[68:69]
v_pk_add_f32 v[150:151], v[150:151], v[70:71]
v_pk_add_f32 v[152:153], v[152:153], v[72:73]
v_pk_add_f32 v[154:155], v[154:155], v[74:75]
v_pk_add_f32 v[156:157], v[156:157], v[76:77]
v_pk_add_f32 v[158:159], v[158:159], v[78:79]
s_waitcnt vmcnt(12)
v_pk_add_f32 v[144:145], v[144:145], v[80:81]
v_pk_add_f32 v[146:147], v[146:147], v[82:83]
v_pk_add_f32 v[148:149], v[148:149], v[84:85]
v_pk_add_f32 v[150:151], v[150:151], v[86:87]
v_pk_add_f32 v[152:153], v[152:153], v[88:89]
v_pk_add_f32 v[154:155], v[154:155], v[90:91]
v_pk_add_f32 v[156:157], v[156:157], v[92:93]
v_pk_add_f32 v[158:159], v[158:159], v[94:95]
s_waitcnt vmcnt(8)
v_pk_add_f32 v[144:145], v[144:145], v[96:97]
v_pk_add_f32 v[146:147], v[146:147], v[98:99]
v_pk_add_f32 v[148:149], v[148:149], v[100:101]
v_pk_add_f32 v[150:151], v[150:151], v[102:103]
v_pk_add_f32 v[152:153], v[152:153], v[104:105]
v_pk_add_f32 v[154:155], v[154:155], v[106:107]
v_pk_add_f32 v[156:157], v[156:157], v[108:109]
v_pk_add_f32 v[158:159], v[158:159], v[110:111]
s_waitcnt vmcnt(4)
v_pk_add_f32 v[144:145], v[144:145], v[112:113]
v_pk_add_f32 v[146:147], v[146:147], v[114:115]
v_pk_add_f32 v[148:149], v[148:149], v[116:117]
v_pk_add_f32 v[150:151], v[150:151], v[118:119]
v_pk_add_f32 v[152:153], v[152:153], v[120:121]
v_pk_add_f32 v[154:155], v[154:155], v[122:123]
v_pk_add_f32 v[156:157], v[156:157], v[124:125]
v_pk_add_f32 v[158:159], v[158:159], v[126:127]
s_waitcnt vmcnt(0)
v_pk_add_f32 v[144:145], v[144:145], v[128:129]
v_pk_add_f32 v[146:147], v[146:147], v[130:131]
v_pk_add_f32 v[148:149], v[148:149], v[132:133]
v_pk_add_f32 v[150:151], v[150:151], v[134:135]
v_pk_add_f32 v[152:153], v[152:153], v[136:137]
v_pk_add_f32 v[154:155], v[154:155], v[138:139]
v_pk_add_f32 v[156:157], v[156:157], v[140:141]
v_pk_add_f32 v[158:159], v[158:159], v[142:143]
v_mov_b32 v14, 159896
s_mov_b32 s25, 0
sw_151:
ds_read_b32 v15, v14
s_add_u32 s25, s25, 1
s_waitcnt lgkmcnt(0)
v_readfirstlane_b32 s24, v15
s_cmp_ge_u32 s24, 4
s_cbranch_scc1 swd_152
s_cmp_lt_u32 s25, 4000000
s_cbranch_scc1 sw_151
swd_152:
s_lshl_b32 s18, s8, 12
v_add_u32 v9, s18, v5
ds_write_b128 v9, v[144:147] offset:0
ds_write_b128 v9, v[148:151] offset:1024
ds_write_b128 v9, v[152:155] offset:2048
ds_write_b128 v9, v[156:159] offset:3072
s_waitcnt lgkmcnt(0)
v_mov_b32 v14, 159872
v_mov_b32 v15, 1
s_mov_b64 exec, 1
ds_add_u32 v14, v15
s_mov_b64 exec, -1
v_mov_b32 v14, 159872
s_mov_b32 s25, 0
sw_153:
ds_read_b32 v15, v14
s_add_u32 s25, s25, 1
s_waitcnt lgkmcnt(0)
v_readfirstlane_b32 s24, v15
s_cmp_ge_u32 s24, 4
s_cbranch_scc1 swd_154
s_cmp_lt_u32 s25, 4000000
s_cbranch_scc1 sw_153
swd_154:
s_cmp_eq_u32 s8, 0
s_cbranch_scc0 gated_mix__linear_kernel_hedgehog__mixer_token_mlp__prompt_kernel_red_done
ds_read_b128 v[16:19], v5 offset:0
ds_read_b128 v[20:23], v5 offset:1024
ds_read_b128 v[24:27], v5 offset:2048
ds_read_b128 v[28:31], v5 offset:3072
ds_read_b128 v[32:35], v5 offset:4096
ds_read_b128 v[36:39], v5 offset:5120
ds_read_b128 v[40:43], v5 offset:6144
ds_read_b128 v[44:47], v5 offset:7168
ds_read_b128 v[48:51], v5 offset:8192
ds_read_b128 v[52:55], v5 offset:9216
ds_read_b128 v[56:59], v5 offset:10240
ds_read_b128 v[60:63], v5 offset:11264
ds_read_b128 v[64:67], v5 offset:12288
ds_read_b128 v[68:71], v5 offset:13312
ds_read_b128 v[72:75], v5 offset:14336
ds_read_b128 v[76:79], v5 offset:15360
s_lshl_b32 s16, s21, 11
s_add_u32 s16, s16, 0x1400000
s_waitcnt lgkmcnt(0)
v_pk_add_f32 v[16:17], v[16:17], v[32:33]
v_pk_add_f32 v[18:19], v[18:19], v[34:35]
v_pk_add_f32 v[20:21], v[20:21], v[36:37]
v_pk_add_f32 v[22:23], v[22:23], v[38:39]
v_pk_add_f32 v[24:25], v[24:25], v[40:41]
v_pk_add_f32 v[26:27], v[26:27], v[42:43]
v_pk_add_f32 v[28:29], v[28:29], v[44:45]
v_pk_add_f32 v[30:31], v[30:31], v[46:47]
v_pk_add_f32 v[48:49], v[48:49], v[64:65]
v_pk_add_f32 v[50:51], v[50:51], v[66:67]
v_pk_add_f32 v[52:53], v[52:53], v[68:69]
v_pk_add_f32 v[54:55], v[54:55], v[70:71]
v_pk_add_f32 v[56:57], v[56:57], v[72:73]
v_pk_add_f32 v[58:59], v[58:59], v[74:75]
v_pk_add_f32 v[60:61], v[60:61], v[76:77]
v_pk_add_f32 v[62:63], v[62:63], v[78:79]
v_pk_add_f32 v[16:17], v[16:17], v[48:49]
v_pk_add_f32 v[18:19], v[18:19], v[50:51]
v_pk_add_f32 v[20:21], v[20:21], v[52:53]
v_pk_add_f32 v[22:23], v[22:23], v[54:55]
v_pk_add_f32 v[24:25], v[24:25], v[56:57]
v_pk_add_f32 v[26:27], v[26:27], v[58:59]
v_pk_add_f32 v[28:29], v[28:29], v[60:61]
v_pk_add_f32 v[30:31], v[30:31], v[62:63]
v_cvt_pk_bf16_f32 v144, v16, v17
v_cvt_pk_bf16_f32 v145, v18, v19
v_cvt_pk_bf16_f32 v146, v20, v21
v_cvt_pk_bf16_f32 v147, v22, v23
v_cvt_pk_bf16_f32 v148, v24, v25
v_cvt_pk_bf16_f32 v149, v26, v27
v_cvt_pk_bf16_f32 v150, v28, v29
v_cvt_pk_bf16_f32 v151, v30, v31
buffer_store_dwordx4 v[144:147], v5, s[28:31], s16 offen sc1
buffer_store_dwordx4 v[148:151], v5, s[28:31], s16 offen offset:1024 sc1
s_waitcnt vmcnt(0)
s_lshl_b32 s24, s21, 6
s_add_u32 s24, s24, 0x180c000
v_mov_b32 v14, s9
v_mov_b32 v15, 0
s_mov_b64 exec, 1
buffer_store_dword v14, v15, s[28:31], s24 offen sc1
s_mov_b64 exec, -1
gated_mix__linear_kernel_hedgehog__mixer_token_mlp__prompt_kernel_red_done:
v_mov_b32 v14, 159876
v_mov_b32 v15, 1
s_mov_b64 exec, 1
ds_add_u32 v14, v15
s_mov_b64 exec, -1
v_mov_b32 v14, 159876
s_mov_b32 s25, 0
sw_155:
ds_read_b32 v15, v14
s_add_u32 s25, s25, 1
s_waitcnt lgkmcnt(0)
v_readfirstlane_b32 s24, v15
s_cmp_ge_u32 s24, 4
s_cbranch_scc1 swd_156
s_cmp_lt_u32 s25, 4000000
s_cbranch_scc1 sw_155
swd_156:
s_branch gated_mix__linear_kernel_hedgehog__mixer_token_mlp__prompt_kernel_noB1
gated_mix__linear_kernel_hedgehog__mixer_token_mlp__prompt_kernel_toucher:
s_sub_u32 s16, s7, 26
s_lshl_b32 s16, s16, 2
s_add_u32 s16, s16, s8
s_lshl_b32 s16, s16, 6
v_add_u32 v8, s16, v0
v_add_u32 v9, 0, v8
v_and_b32 v12, 3, v9
v_lshrrev_b32 v9, 2, v9
v_add_u32 v9, 640, v9
v_lshlrev_b32 v9, 12, v9
v_lshl_add_u32 v9, v12, 7, v9
s_lshl_b32 s18, s6, 9
buffer_load_dword v13, v9, s[52:55], s18 offen
v_add_u32 v9, 1536, v8
v_and_b32 v12, 3, v9
v_lshrrev_b32 v9, 2, v9
v_add_u32 v9, 640, v9
v_lshlrev_b32 v9, 12, v9
v_lshl_add_u32 v9, v12, 7, v9
s_lshl_b32 s18, s6, 9
buffer_load_dword v13, v9, s[52:55], s18 offen
v_lshlrev_b32 v9, 7, v8
s_and_b32 s18, s6, 1
s_lshl_b32 s18, s18, 18
buffer_load_dword v13, v9, s[56:59], s18 offen
v_add_u32 v9, 196608, v9
v_cmp_gt_u32 vcc, 512, v8
v_add_u32 v12, 0x40000000, v9
s_nop 0
v_cndmask_b32 v9, v12, v9, vcc
buffer_load_dword v13, v9, s[56:59], s18 offen
gated_mix__linear_kernel_hedgehog__mixer_token_mlp__prompt_kernel_noB1:
v_lshrrev_b32 v6, 3, v0
v_and_b32 v7, 7, v0
v_bfe_u32 v9, v0, 4, 1
v_lshlrev_b32 v9, 2, v9
v_xor_b32 v7, v7, v9
v_lshlrev_b32 v7, 4, v7
v_lshl_add_u32 v2, v6, 12, v7
v_lshl_add_u32 v3, v6, 10, v7
s_lshl_b32 s19, s8, 11
s_lshl_b32 s17, s8, 16
s_lshl_b32 s18, s80, 1
s_add_u32 s17, s17, s18
s_lshl_b32 s16, s8, 14
s_lshl_b32 s18, s81, 10
s_add_u32 s16, s16, s18
v_mov_b32 v14, 159896
s_mov_b32 s25, 0
sw_157:
ds_read_b32 v15, v14
s_add_u32 s25, s25, 1
s_waitcnt lgkmcnt(0)
v_readfirstlane_b32 s24, v15
s_cmp_ge_u32 s24, 4
s_cbranch_scc1 swd_158
s_cmp_lt_u32 s25, 4000000
s_cbranch_scc1 sw_157
swd_158:
s_add_u32 m0, s19, 8192
s_add_u32 s18, s17, 32768
buffer_load_dwordx4 v2, s[52:55], s17 offen  lds
s_add_u32 m0, m0, 1024
s_add_u32 s17, s17, 262144
buffer_load_dwordx4 v2, s[52:55], s18 offen  lds
s_add_u32 m0, s19, 24576
s_add_u32 s18, s17, 32768
buffer_load_dwordx4 v2, s[52:55], s17 offen  lds
s_add_u32 m0, m0, 1024
s_add_u32 s17, s17, 262144
buffer_load_dwordx4 v2, s[52:55], s18 offen  lds
s_cmp_ge_u32 s7, 22
s_cbranch_scc1 gated_mix__linear_kernel_hedgehog__mixer_token_mlp__prompt_kernel_noFU
s_waitcnt vmcnt(4)
v_mov_b32 v14, 159880
v_mov_b32 v15, 1
s_mov_b64 exec, 1
ds_add_u32 v14, v15
s_mov_b64 exec, -1
v_mov_b32 v14, 159880
s_mov_b32 s25, 0
sw_159:
ds_read_b32 v15, v14
s_add_u32 s25, s25, 1
s_waitcnt lgkmcnt(0)
v_readfirstlane_b32 s24, v15
s_cmp_ge_u32 s24, 4
s_cbranch_scc1 swd_160
s_cmp_lt_u32 s25, 4000000
s_cbranch_scc1 sw_159
swd_160:
s_cmp_eq_u32 s8, 0
s_cbranch_scc0 gated_mix__linear_kernel_hedgehog__mixer_token_mlp__prompt_kernel_noFU
s_lshl_b32 s24, s22, 5
s_add_u32 s24, s24, s21
s_lshl_b32 s24, s24, 6
s_add_u32 s24, s24, 0x1810000
v_mov_b32 v14, s9
v_mov_b32 v15, 0
s_mov_b64 exec, 1
buffer_store_dword v14, v15, s[28:31], s24 offen sc1
s_mov_b64 exec, -1
gated_mix__linear_kernel_hedgehog__mixer_token_mlp__prompt_kernel_noFU:
s_add_u32 m0, s19, 40960
s_add_u32 s18, s17, 32768
buffer_load_dwordx4 v2, s[52:55], s17 offen  lds
s_add_u32 m0, m0, 1024
s_add_u32 s17, s17, 262144
buffer_load_dwordx4 v2, s[52:55], s18 offen  lds
s_add_u32 m0, s19, 57344
s_add_u32 s18, s17, 32768
buffer_load_dwordx4 v2, s[52:55], s17 offen  lds
s_add_u32 m0, m0, 1024
s_add_u32 s17, s17, 262144
buffer_load_dwordx4 v2, s[52:55], s18 offen  lds
s_add_u32 m0, s19, 73728
s_add_u32 s18, s17, 32768
buffer_load_dwordx4 v2, s[52:55], s17 offen  lds
s_add_u32 m0, m0, 1024
s_add_u32 s17, s17, 262144
buffer_load_dwordx4 v2, s[52:55], s18 offen  lds
s_add_u32 m0, s19, 90112
s_add_u32 s18, s17, 32768
buffer_load_dwordx4 v2, s[52:55], s17 offen  lds
s_add_u32 m0, m0, 1024
s_add_u32 s17, s17, 262144
buffer_load_dwordx4 v2, s[52:55], s18 offen  lds
s_add_u32 m0, s19, 106496
s_add_u32 s18, s17, 32768
buffer_load_dwordx4 v2, s[52:55], s17 offen  lds
s_add_u32 m0, m0, 1024
s_add_u32 s17, s17, 262144
buffer_load_dwordx4 v2, s[52:55], s18 offen  lds
s_add_u32 m0, s19, 122880
s_add_u32 s18, s17, 32768
buffer_load_dwordx4 v2, s[52:55], s17 offen  lds
s_add_u32 m0, m0, 1024
s_add_u32 s17, s17, 262144
buffer_load_dwordx4 v2, s[52:55], s18 offen  lds
s_cmp_eq_u32 s8, 0
s_cbranch_scc0 nfu_161
v_min_u32 v10, 21, v0
v_lshlrev_b32 v10, 6, v10
s_lshl_b32 s23, s81, 11
s_add_u32 s23, s23, 0x1810000
s_mov_b32 s26, 0
pl_162:
buffer_load_dword v11, v10, s[28:31], s23 offen sc1
s_waitcnt vmcnt(0)
v_cmp_eq_u32 s[4:5], s9, v11
s_add_u32 s26, s26, 1
s_nop 0
s_and_b32 s24, s4, 0x7
s_cmp_eq_u32 s24, 0x7
s_cbranch_scc1 plok_163
s_cmp_lt_u32 s26, 60000
s_cbranch_scc1 pl_162
plok_163:
nfu_161:
s_barrier
s_add_u32 m0, s19, 0
s_add_u32 s18, s16, 8192
buffer_load_dwordx4 v5, s[44:47], s16 offen sc1 lds
s_add_u32 m0, m0, 1024
s_add_u32 s16, s16, 65536
buffer_load_dwordx4 v5, s[44:47], s18 offen sc1 lds
s_add_u32 m0, s19, 16384
s_add_u32 s18, s16, 8192
buffer_load_dwordx4 v5, s[44:47], s16 offen sc1 lds
s_add_u32 m0, m0, 1024
s_add_u32 s16, s16, 65536
buffer_load_dwordx4 v5, s[44:47], s18 offen sc1 lds
s_add_u32 m0, s19, 32768
s_add_u32 s18, s16, 8192
buffer_load_dwordx4 v5, s[44:47], s16 offen sc1 lds
s_add_u32 m0, m0, 1024
s_add_u32 s16, s16, 65536
buffer_load_dwordx4 v5, s[44:47], s18 offen sc1 lds
s_waitcnt vmcnt(4)
s_cmp_eq_u32 s8, 0
s_cbranch_scc0 nfu_164
s_and_b32 s24, s4, 0xf
s_cmp_eq_u32 s24, 0xf
s_cbranch_scc1 nfu_164
s_mov_b32 s26, 0
pl_165:
buffer_load_dword v11, v10, s[28:31], s23 offen sc1
s_waitcnt vmcnt(0)
v_cmp_eq_u32 s[4:5], s9, v11
s_add_u32 s26, s26, 1
s_nop 0
s_and_b32 s24, s4, 0xf
s_cmp_eq_u32 s24, 0xf
s_cbranch_scc1 plok_166
s_cmp_lt_u32 s26, 60000
s_cbranch_scc1 pl_165
plok_166:
nfu_164:
s_barrier
s_add_u32 m0, s19, 49152
s_add_u32 s18, s16, 8192
buffer_load_dwordx4 v5, s[44:47], s16 offen sc1 lds
s_add_u32 m0, m0, 1024
s_add_u32 s16, s16, 65536
buffer_load_dwordx4 v5, s[44:47], s18 offen sc1 lds
s_cmp_eq_u32 s8, 0
s_cbranch_scc0 ifu_167
buffer_load_dword v13, v10, s[28:31], s23 offen sc1
ifu_167:
s_waitcnt vmcnt(4)
s_cmp_eq_u32 s8, 0
s_cbranch_scc0 nfu_168
s_and_b32 s24, s4, 0x1f
s_cmp_eq_u32 s24, 0x1f
s_cbranch_scc1 nfu_168
s_mov_b32 s26, 0
pl_169:
buffer_load_dword v11, v10, s[28:31], s23 offen sc1
s_waitcnt vmcnt(0)
v_cmp_eq_u32 s[4:5], s9, v11
s_add_u32 s26, s26, 1
s_nop 0
s_and_b32 s24, s4, 0x1f
s_cmp_eq_u32 s24, 0x1f
s_cbranch_scc1 plok_170
s_cmp_lt_u32 s26, 60000
s_cbranch_scc1 pl_169
plok_170:
nfu_168:
s_barrier
s_add_u32 m0, s19, 65536
s_add_u32 s18, s16, 8192
buffer_load_dwordx4 v5, s[44:47], s16 offen sc1 lds
s_add_u32 m0, m0, 1024
s_add_u32 s16, s16, 65536
buffer_load_dwordx4 v5, s[44:47], s18 offen sc1 lds
s_add_u32 m0, s19, 8192
s_add_u32 s18, s17, 32768
buffer_load_dwordx4 v2, s[52:55], s17 offen  lds
s_add_u32 m0, m0, 1024
s_add_u32 s17, s17, 262144
buffer_load_dwordx4 v2, s[52:55], s18 offen  lds
s_waitcnt vmcnt(6)
s_cmp_eq_u32 s8, 0
s_cbranch_scc0 nfu_171
s_and_b32 s24, s4, 0x3f
s_cmp_eq_u32 s24, 0x3f
s_cbranch_scc1 nfu_171
s_mov_b32 s26, 0
pl_172:
buffer_load_dword v11, v10, s[28:31], s23 offen sc1
s_waitcnt vmcnt(0)
v_cmp_eq_u32 s[4:5], s9, v11
s_add_u32 s26, s26, 1
s_nop 0
s_and_b32 s24, s4, 0x3f
s_cmp_eq_u32 s24, 0x3f
s_cbranch_scc1 plok_173
s_cmp_lt_u32 s26, 60000
s_cbranch_scc1 pl_172
plok_173:
nfu_171:
s_barrier
s_add_u32 m0, s19, 81920
s_add_u32 s18, s16, 8192
buffer_load_dwordx4 v5, s[44:47], s16 offen sc1 lds
s_add_u32 m0, m0, 1024
s_add_u32 s16, s16, 65536
buffer_load_dwordx4 v5, s[44:47], s18 offen sc1 lds
s_add_u32 m0, s19, 24576
s_add_u32 s18, s17, 32768
buffer_load_dwordx4 v2, s[52:55], s17 offen  lds
s_add_u32 m0, m0, 1024
s_add_u32 s17, s17, 262144
buffer_load_dwordx4 v2, s[52:55], s18 offen  lds
v_and_b32 v8, 1, v0
v_lshlrev_b32 v8, 6, v8
s_lshl_b32 s101, s11, 1
s_add_u32 s101, s101, s13
s_lshl_b32 s101, s101, 7
s_add_u32 s101, s101, 0x180c000
buffer_load_dword v12, v8, s[28:31], s101 offen sc1
s_waitcnt vmcnt(9)
s_cmp_eq_u32 s8, 0
s_cbranch_scc0 rfu_174
s_waitcnt vmcnt(9)
v_cmp_eq_u32 s[4:5], s9, v13
s_nop 1
rfu_174:
s_cmp_eq_u32 s8, 0
s_cbranch_scc0 nfu_175
s_and_b32 s24, s4, 0x7f
s_cmp_eq_u32 s24, 0x7f
s_cbranch_scc1 nfu_175
s_mov_b32 s26, 0
pl_176:
buffer_load_dword v11, v10, s[28:31], s23 offen sc1
s_waitcnt vmcnt(0)
v_cmp_eq_u32 s[4:5], s9, v11
s_add_u32 s26, s26, 1
s_nop 0
s_and_b32 s24, s4, 0x7f
s_cmp_eq_u32 s24, 0x7f
s_cbranch_scc1 plok_177
s_cmp_lt_u32 s26, 60000
s_cbranch_scc1 pl_176
plok_177:
nfu_175:
s_barrier
s_add_u32 m0, s19, 98304
s_add_u32 s18, s16, 8192
buffer_load_dwordx4 v5, s[44:47], s16 offen sc1 lds
s_add_u32 m0, m0, 1024
s_add_u32 s16, s16, 65536
buffer_load_dwordx4 v5, s[44:47], s18 offen sc1 lds
s_add_u32 m0, s19, 40960
s_add_u32 s18, s17, 32768
buffer_load_dwordx4 v2, s[52:55], s17 offen  lds
s_add_u32 m0, m0, 1024
s_add_u32 s17, s17, 262144
buffer_load_dwordx4 v2, s[52:55], s18 offen  lds
s_cmp_eq_u32 s8, 0
s_cbranch_scc0 ifu_178
buffer_load_dword v13, v10, s[28:31], s23 offen sc1
ifu_178:
s_waitcnt vmcnt(11)
s_cmp_eq_u32 s8, 0
s_cbranch_scc0 nfu_179
s_and_b32 s24, s4, 0xff
s_cmp_eq_u32 s24, 0xff
s_cbranch_scc1 nfu_179
s_mov_b32 s26, 0
pl_180:
buffer_load_dword v11, v10, s[28:31], s23 offen sc1
s_waitcnt vmcnt(0)
v_cmp_eq_u32 s[4:5], s9, v11
s_add_u32 s26, s26, 1
s_nop 0
s_and_b32 s24, s4, 0xff
s_cmp_eq_u32 s24, 0xff
s_cbranch_scc1 plok_181
s_cmp_lt_u32 s26, 60000
s_cbranch_scc1 pl_180
plok_181:
nfu_179:
s_barrier
s_add_u32 m0, s19, 114688
s_add_u32 s18, s16, 8192
buffer_load_dwordx4 v5, s[44:47], s16 offen sc1 lds
s_add_u32 m0, m0, 1024
s_add_u32 s16, s16, 65536
buffer_load_dwordx4 v5, s[44:47], s18 offen sc1 lds
s_add_u32 m0, s19, 57344
s_add_u32 s18, s17, 32768
buffer_load_dwordx4 v2, s[52:55], s17 offen  lds
s_add_u32 m0, m0, 1024
s_add_u32 s17, s17, 262144
buffer_load_dwordx4 v2, s[52:55], s18 offen  lds
s_waitcnt vmcnt(8)
v_cmp_eq_u32 s[6:7], s9, v12
s_nop 1
s_cmp_eq_u64 s[6:7], exec
s_cbranch_scc1 f2ok_182
s_mov_b32 s26, 0
pl_183:
buffer_load_dword v12, v8, s[28:31], s101 offen sc1
s_waitcnt vmcnt(0)
v_cmp_eq_u32 s[6:7], s9, v12
s_add_u32 s26, s26, 1
s_nop 0
s_cmp_eq_u64 s[6:7], exec
s_cbranch_scc1 plok_184
s_cmp_lt_u32 s26, 60000
s_cbranch_scc1 pl_183
plok_184:
f2ok_182:
s_lshl_b32 s101, s11, 2
s_lshl_b32 s18, s13, 1
s_add_u32 s101, s101, s18
s_lshl_b32 s101, s101, 11
s_add_u32 s101, s101, 0x1400000
buffer_load_dwordx4 v[16:19], v5, s[28:31], s101 offen offset:0 sc1
buffer_load_dwordx4 v[20:23], v5, s[28:31], s101 offen offset:1024 sc1
s_add_u32 s101, s101, 2048
buffer_load_dwordx4 v[24:27], v5, s[28:31], s101 offen offset:0 sc1
buffer_load_dwordx4 v[28:31], v5, s[28:31], s101 offen offset:1024 sc1
s_lshl_b32 s18, s8, 12
s_add_u32 s18, s18, 133120
v_add_u32 v9, s18, v5
ds_read_b128 v[32:35], v9 offset:0
ds_read_b128 v[36:39], v9 offset:1024
ds_read_b128 v[40:43], v9 offset:2048
ds_read_b128 v[44:47], v9 offset:3072
s_waitcnt vmcnt(15)
s_cmp_eq_u32 s8, 0
s_cbranch_scc0 nfu_185
s_and_b32 s24, s4, 0x1ff
s_cmp_eq_u32 s24, 0x1ff
s_cbranch_scc1 nfu_185
s_mov_b32 s26, 0
pl_186:
buffer_load_dword v11, v10, s[28:31], s23 offen sc1
s_waitcnt vmcnt(0)
v_cmp_eq_u32 s[4:5], s9, v11
s_add_u32 s26, s26, 1
s_nop 0
s_and_b32 s24, s4, 0x1ff
s_cmp_eq_u32 s24, 0x1ff
s_cbranch_scc1 plok_187
s_cmp_lt_u32 s26, 60000
s_cbranch_scc1 pl_186
plok_187:
nfu_185:
s_barrier
s_add_u32 m0, s19, 0
s_add_u32 s18, s16, 8192
buffer_load_dwordx4 v5, s[44:47], s16 offen sc1 lds
s_add_u32 m0, m0, 1024
s_add_u32 s16, s16, 65536
buffer_load_dwordx4 v5, s[44:47], s18 offen sc1 lds
s_add_u32 m0, s19, 73728
s_add_u32 s18, s17, 32768
buffer_load_dwordx4 v2, s[52:55], s17 offen  lds
s_add_u32 m0, m0, 1024
s_add_u32 s17, s17, 262144
buffer_load_dwordx4 v2, s[52:55], s18 offen  lds
s_waitcnt vmcnt(14)
s_cmp_eq_u32 s8, 0
s_cbranch_scc0 rfu_188
s_waitcnt vmcnt(12)
v_cmp_eq_u32 s[4:5], s9, v13
s_nop 1
rfu_188:
s_cmp_eq_u32 s8, 0
s_cbranch_scc0 nfu_189
s_and_b32 s24, s4, 0x3ff
s_cmp_eq_u32 s24, 0x3ff
s_cbranch_scc1 nfu_189
s_mov_b32 s26, 0
pl_190:
buffer_load_dword v11, v10, s[28:31], s23 offen sc1
s_waitcnt vmcnt(0)
v_cmp_eq_u32 s[4:5], s9, v11
s_add_u32 s26, s26, 1
s_nop 0
s_and_b32 s24, s4, 0x3ff
s_cmp_eq_u32 s24, 0x3ff
s_cbranch_scc1 plok_191
s_cmp_lt_u32 s26, 60000
s_cbranch_scc1 pl_190
plok_191:
nfu_189:
s_barrier
s_add_u32 m0, s19, 16384
s_add_u32 s18, s16, 8192
buffer_load_dwordx4 v5, s[44:47], s16 offen sc1 lds
s_add_u32 m0, m0, 1024
s_add_u32 s16, s16, 65536
buffer_load_dwordx4 v5, s[44:47], s18 offen sc1 lds
s_add_u32 m0, s19, 90112
s_add_u32 s18, s17, 32768
buffer_load_dwordx4 v2, s[52:55], s17 offen  lds
s_add_u32 m0, m0, 1024
s_add_u32 s17, s17, 262144
buffer_load_dwordx4 v2, s[52:55], s18 offen  lds
s_waitcnt vmcnt(8)
s_waitcnt lgkmcnt(0)
v_mfma_f32_32x32x16_bf16 v[48:63], v[16:19], v[32:35], 0
v_mfma_f32_32x32x16_bf16 v[48:63], v[20:23], v[36:39], v[48:63]
v_mfma_f32_32x32x16_bf16 v[64:79], v[24:27], v[40:43], 0
v_mfma_f32_32x32x16_bf16 v[64:79], v[28:31], v[44:47], v[64:79]
v_and_b32 v14, 31, v0
v_lshrrev_b32 v15, 5, v0
s_lshl_b32 s18, s11, 2
s_lshl_b32 s101, s13, 1
s_add_u32 s18, s18, s101
s_lshl_b32 s18, s18, 1
v_add_u32 v7, s18, v15
v_lshlrev_b32 v7, 11, v7
s_lshl_b32 s18, s14, 5
s_add_u32 s18, s18, s10
v_add3_u32 v7, v7, v14, s18
v_lshlrev_b32 v7, 4, v7
s_cmp_eq_u32 s8, 0
s_cbranch_scc0 ifu_192
buffer_load_dword v13, v10, s[28:31], s23 offen sc1
ifu_192:
s_waitcnt vmcnt(14)
s_cmp_eq_u32 s8, 0
s_cbranch_scc0 nfu_193
s_and_b32 s24, s4, 0x7ff
s_cmp_eq_u32 s24, 0x7ff
s_cbranch_scc1 nfu_193
s_mov_b32 s26, 0
pl_194:
buffer_load_dword v11, v10, s[28:31], s23 offen sc1
s_waitcnt vmcnt(0)
v_cmp_eq_u32 s[4:5], s9, v11
s_add_u32 s26, s26, 1
s_nop 0
s_and_b32 s24, s4, 0x7ff
s_cmp_eq_u32 s24, 0x7ff
s_cbranch_scc1 plok_195
s_cmp_lt_u32 s26, 60000
s_cbranch_scc1 pl_194
plok_195:
nfu_193:
s_barrier
s_mov_b32 s101, 0x358637bd
v_add_f32 v56, s101, v56
v_rcp_f32 v56, v56
s_nop 0
v_mul_f32 v48, v48, v56
v_mul_f32 v49, v49, v56
v_mul_f32 v50, v50, v56
v_mul_f32 v51, v51, v56
v_mul_f32 v52, v52, v56
v_mul_f32 v53, v53, v56
v_mul_f32 v54, v54, v56
v_mul_f32 v55, v55, v56
v_cvt_pk_bf16_f32 v80, v48, v49
v_cvt_pk_bf16_f32 v81, v50, v51
v_cvt_pk_bf16_f32 v82, v52, v53
v_cvt_pk_bf16_f32 v83, v54, v55
v_add_f32 v72, s101, v72
v_rcp_f32 v72, v72
s_nop 0
v_mul_f32 v64, v64, v72
v_mul_f32 v65, v65, v72
v_mul_f32 v66, v66, v72
v_mul_f32 v67, v67, v72
v_mul_f32 v68, v68, v72
v_mul_f32 v69, v69, v72
v_mul_f32 v70, v70, v72
v_mul_f32 v71, v71, v72
v_cvt_pk_bf16_f32 v84, v64, v65
v_cvt_pk_bf16_f32 v85, v66, v67
v_cvt_pk_bf16_f32 v86, v68, v69
v_cvt_pk_bf16_f32 v87, v70, v71
s_nop 1
v_permlane32_swap_b32 v80, v82
v_permlane32_swap_b32 v81, v83
v_permlane32_swap_b32 v84, v86
v_permlane32_swap_b32 v85, v87
s_mov_b32 s101, 0x1100000
s_nop 0
buffer_store_dwordx4 v[80:83], v7, s[28:31], s101 offen sc1
s_add_u32 s101, s101, 65536
buffer_store_dwordx4 v[84:87], v7, s[28:31], s101 offen sc1
s_add_u32 m0, s19, 32768
s_add_u32 s18, s16, 8192
buffer_load_dwordx4 v5, s[44:47], s16 offen sc1 lds
s_add_u32 m0, m0, 1024
s_add_u32 s16, s16, 65536
buffer_load_dwordx4 v5, s[44:47], s18 offen sc1 lds
s_add_u32 m0, s19, 106496
s_add_u32 s18, s17, 32768
buffer_load_dwordx4 v2, s[52:55], s17 offen  lds
s_add_u32 m0, m0, 1024
s_add_u32 s17, s17, 262144
buffer_load_dwordx4 v2, s[52:55], s18 offen  lds
s_waitcnt vmcnt(12)
s_cmp_eq_u32 s8, 0
s_cbranch_scc0 nfu_196
s_and_b32 s24, s4, 0xfff
s_cmp_eq_u32 s24, 0xfff
s_cbranch_scc1 nfu_196
s_mov_b32 s26, 0
pl_197:
buffer_load_dword v11, v10, s[28:31], s23 offen sc1
s_waitcnt vmcnt(0)
v_cmp_eq_u32 s[4:5], s9, v11
s_add_u32 s26, s26, 1
s_nop 0
s_and_b32 s24, s4, 0xfff
s_cmp_eq_u32 s24, 0xfff
s_cbranch_scc1 plok_198
s_cmp_lt_u32 s26, 60000
s_cbranch_scc1 pl_197
plok_198:
nfu_196:
s_barrier
s_add_u32 m0, s19, 49152
s_add_u32 s18, s16, 8192
buffer_load_dwordx4 v5, s[44:47], s16 offen sc1 lds
s_add_u32 m0, m0, 1024
s_add_u32 s16, s16, 65536
buffer_load_dwordx4 v5, s[44:47], s18 offen sc1 lds
s_add_u32 m0, s19, 122880
s_add_u32 s18, s17, 32768
buffer_load_dwordx4 v2, s[52:55], s17 offen  lds
s_add_u32 m0, m0, 1024
s_add_u32 s17, s17, 262144
buffer_load_dwordx4 v2, s[52:55], s18 offen  lds
s_waitcnt vmcnt(12)
s_cmp_eq_u32 s8, 0
s_cbranch_scc0 rfu_199
s_waitcnt vmcnt(10)
v_cmp_eq_u32 s[4:5], s9, v13
s_nop 1
rfu_199:
s_cmp_eq_u32 s8, 0
s_cbranch_scc0 nfu_200
s_and_b32 s24, s4, 0x1fff
s_cmp_eq_u32 s24, 0x1fff
s_cbranch_scc1 nfu_200
s_mov_b32 s26, 0
pl_201:
buffer_load_dword v11, v10, s[28:31], s23 offen sc1
s_waitcnt vmcnt(0)
v_cmp_eq_u32 s[4:5], s9, v11
s_add_u32 s26, s26, 1
s_nop 0
s_and_b32 s24, s4, 0x1fff
s_cmp_eq_u32 s24, 0x1fff
s_cbranch_scc1 plok_202
s_cmp_lt_u32 s26, 60000
s_cbranch_scc1 pl_201
plok_202:
nfu_200:
s_barrier
s_add_u32 m0, s19, 65536
s_add_u32 s18, s16, 8192
buffer_load_dwordx4 v5, s[44:47], s16 offen sc1 lds
s_add_u32 m0, m0, 1024
s_add_u32 s16, s16, 65536
buffer_load_dwordx4 v5, s[44:47], s18 offen sc1 lds
s_add_u32 m0, s19, 8192
s_add_u32 s18, s17, 32768
buffer_load_dwordx4 v2, s[52:55], s17 offen  lds
s_add_u32 m0, m0, 1024
s_add_u32 s17, s17, 262144
buffer_load_dwordx4 v2, s[52:55], s18 offen  lds
s_cmp_eq_u32 s8, 0
s_cbranch_scc0 ifu_203
buffer_load_dword v13, v10, s[28:31], s23 offen sc1
ifu_203:
s_waitcnt vmcnt(10)
s_cmp_eq_u32 s8, 0
s_cbranch_scc0 nfu_204
s_and_b32 s24, s4, 0x3fff
s_cmp_eq_u32 s24, 0x3fff
s_cbranch_scc1 nfu_204
s_mov_b32 s26, 0
pl_205:
buffer_load_dword v11, v10, s[28:31], s23 offen sc1
s_waitcnt vmcnt(0)
v_cmp_eq_u32 s[4:5], s9, v11
s_add_u32 s26, s26, 1
s_nop 0
s_and_b32 s24, s4, 0x3fff
s_cmp_eq_u32 s24, 0x3fff
s_cbranch_scc1 plok_206
s_cmp_lt_u32 s26, 60000
s_cbranch_scc1 pl_205
plok_206:
nfu_204:
s_barrier
s_add_u32 m0, s19, 81920
s_add_u32 s18, s16, 8192
buffer_load_dwordx4 v5, s[44:47], s16 offen sc1 lds
s_add_u32 m0, m0, 1024
s_add_u32 s16, s16, 65536
buffer_load_dwordx4 v5, s[44:47], s18 offen sc1 lds
s_add_u32 m0, s19, 24576
s_add_u32 s18, s17, 32768
buffer_load_dwordx4 v2, s[52:55], s17 offen  lds
s_add_u32 m0, m0, 1024
s_add_u32 s17, s17, 262144
buffer_load_dwordx4 v2, s[52:55], s18 offen  lds
s_waitcnt vmcnt(10)
s_cmp_eq_u32 s8, 0
s_cbranch_scc0 nfu_207
s_and_b32 s24, s4, 0x7fff
s_cmp_eq_u32 s24, 0x7fff
s_cbranch_scc1 nfu_207
s_mov_b32 s26, 0
pl_208:
buffer_load_dword v11, v10, s[28:31], s23 offen sc1
s_waitcnt vmcnt(0)
v_cmp_eq_u32 s[4:5], s9, v11
s_add_u32 s26, s26, 1
s_nop 0
s_and_b32 s24, s4, 0x7fff
s_cmp_eq_u32 s24, 0x7fff
s_cbranch_scc1 plok_209
s_cmp_lt_u32 s26, 60000
s_cbranch_scc1 pl_208
plok_209:
nfu_207:
s_barrier
s_add_u32 m0, s19, 98304
s_add_u32 s18, s16, 8192
buffer_load_dwordx4 v5, s[44:47], s16 offen sc1 lds
s_add_u32 m0, m0, 1024
s_add_u32 s16, s16, 65536
buffer_load_dwordx4 v5, s[44:47], s18 offen sc1 lds
s_add_u32 m0, s19, 40960
s_add_u32 s18, s17, 32768
buffer_load_dwordx4 v2, s[52:55], s17 offen  lds
s_add_u32 m0, m0, 1024
s_add_u32 s17, s17, 262144
buffer_load_dwordx4 v2, s[52:55], s18 offen  lds
s_waitcnt vmcnt(10)
s_cmp_eq_u32 s8, 0
s_cbranch_scc0 rfu_210
s_waitcnt vmcnt(8)
v_cmp_eq_u32 s[4:5], s9, v13
s_nop 1
rfu_210:
s_cmp_eq_u32 s8, 0
s_cbranch_scc0 nfu_211
s_and_b32 s24, s4, 0xffff
s_cmp_eq_u32 s24, 0xffff
s_cbranch_scc1 nfu_211
s_mov_b32 s26, 0
pl_212:
buffer_load_dword v11, v10, s[28:31], s23 offen sc1
s_waitcnt vmcnt(0)
v_cmp_eq_u32 s[4:5], s9, v11
s_add_u32 s26, s26, 1
s_nop 0
s_and_b32 s24, s4, 0xffff
s_cmp_eq_u32 s24, 0xffff
s_cbranch_scc1 plok_213
s_cmp_lt_u32 s26, 60000
s_cbranch_scc1 pl_212
plok_213:
nfu_211:
s_barrier
s_add_u32 m0, s19, 114688
s_add_u32 s18, s16, 8192
buffer_load_dwordx4 v5, s[44:47], s16 offen sc1 lds
s_add_u32 m0, m0, 1024
s_add_u32 s16, s16, 65536
buffer_load_dwordx4 v5, s[44:47], s18 offen sc1 lds
s_add_u32 m0, s19, 57344
s_add_u32 s18, s17, 32768
buffer_load_dwordx4 v2, s[52:55], s17 offen  lds
s_add_u32 m0, m0, 1024
s_add_u32 s17, s17, 262144
buffer_load_dwordx4 v2, s[52:55], s18 offen  lds
s_cmp_eq_u32 s8, 0
s_cbranch_scc0 ifu_214
buffer_load_dword v13, v10, s[28:31], s23 offen sc1
ifu_214:
s_waitcnt vmcnt(10)
s_cmp_eq_u32 s8, 0
s_cbranch_scc0 nfu_215
s_and_b32 s24, s4, 0x1ffff
s_cmp_eq_u32 s24, 0x1ffff
s_cbranch_scc1 nfu_215
s_mov_b32 s26, 0
pl_216:
buffer_load_dword v11, v10, s[28:31], s23 offen sc1
s_waitcnt vmcnt(0)
v_cmp_eq_u32 s[4:5], s9, v11
s_add_u32 s26, s26, 1
s_nop 0
s_and_b32 s24, s4, 0x1ffff
s_cmp_eq_u32 s24, 0x1ffff
s_cbranch_scc1 plok_217
s_cmp_lt_u32 s26, 60000
s_cbranch_scc1 pl_216
plok_217:
nfu_215:
s_barrier
s_add_u32 m0, s19, 0
s_add_u32 s18, s16, 8192
buffer_load_dwordx4 v5, s[44:47], s16 offen sc1 lds
s_add_u32 m0, m0, 1024
s_add_u32 s16, s16, 65536
buffer_load_dwordx4 v5, s[44:47], s18 offen sc1 lds
s_add_u32 m0, s19, 73728
s_add_u32 s18, s17, 32768
buffer_load_dwordx4 v2, s[52:55], s17 offen  lds
s_add_u32 m0, m0, 1024
s_add_u32 s17, s17, 262144
buffer_load_dwordx4 v2, s[52:55], s18 offen  lds
s_waitcnt vmcnt(10)
s_cmp_eq_u32 s8, 0
s_cbranch_scc0 nfu_218
s_and_b32 s24, s4, 0x3ffff
s_cmp_eq_u32 s24, 0x3ffff
s_cbranch_scc1 nfu_218
s_mov_b32 s26, 0
pl_219:
buffer_load_dword v11, v10, s[28:31], s23 offen sc1
s_waitcnt vmcnt(0)
v_cmp_eq_u32 s[4:5], s9, v11
s_add_u32 s26, s26, 1
s_nop 0
s_and_b32 s24, s4, 0x3ffff
s_cmp_eq_u32 s24, 0x3ffff
s_cbranch_scc1 plok_220
s_cmp_lt_u32 s26, 60000
s_cbranch_scc1 pl_219
plok_220:
nfu_218:
s_barrier
s_add_u32 m0, s19, 16384
s_add_u32 s18, s16, 8192
buffer_load_dwordx4 v5, s[44:47], s16 offen sc1 lds
s_add_u32 m0, m0, 1024
s_add_u32 s16, s16, 65536
buffer_load_dwordx4 v5, s[44:47], s18 offen sc1 lds
s_add_u32 m0, s19, 90112
s_add_u32 s18, s17, 32768
buffer_load_dwordx4 v2, s[52:55], s17 offen  lds
s_add_u32 m0, m0, 1024
s_add_u32 s17, s17, 262144
buffer_load_dwordx4 v2, s[52:55], s18 offen  lds
s_waitcnt vmcnt(10)
s_cmp_eq_u32 s8, 0
s_cbranch_scc0 rfu_221
s_waitcnt vmcnt(8)
v_cmp_eq_u32 s[4:5], s9, v13
s_nop 1
rfu_221:
s_cmp_eq_u32 s8, 0
s_cbranch_scc0 nfu_222
s_and_b32 s24, s4, 0x7ffff
s_cmp_eq_u32 s24, 0x7ffff
s_cbranch_scc1 nfu_222
s_mov_b32 s26, 0
pl_223:
buffer_load_dword v11, v10, s[28:31], s23 offen sc1
s_waitcnt vmcnt(0)
v_cmp_eq_u32 s[4:5], s9, v11
s_add_u32 s26, s26, 1
s_nop 0
s_and_b32 s24, s4, 0x7ffff
s_cmp_eq_u32 s24, 0x7ffff
s_cbranch_scc1 plok_224
s_cmp_lt_u32 s26, 60000
s_cbranch_scc1 pl_223
plok_224:
nfu_222:
s_barrier
s_add_u32 m0, s19, 32768
s_add_u32 s18, s16, 8192
buffer_load_dwordx4 v5, s[44:47], s16 offen sc1 lds
s_add_u32 m0, m0, 1024
s_add_u32 s16, s16, 65536
buffer_load_dwordx4 v5, s[44:47], s18 offen sc1 lds
s_lshl_b32 s17, s8, 14
s_lshl_b32 s18, s81, 7
s_add_u32 s17, s17, s18
s_add_u32 m0, s19, 98304
s_add_u32 s18, s17, 8192
buffer_load_dwordx4 v3, s[56:59], s17 offen lds
s_add_u32 m0, m0, 1024
s_add_u32 s17, s17, 65536
buffer_load_dwordx4 v3, s[56:59], s18 offen lds
s_waitcnt vmcnt(10)
s_cmp_eq_u32 s8, 0
s_cbranch_scc0 nfu_225
s_and_b32 s24, s4, 0xfffff
s_cmp_eq_u32 s24, 0xfffff
s_cbranch_scc1 nfu_225
s_mov_b32 s26, 0
pl_226:
buffer_load_dword v11, v10, s[28:31], s23 offen sc1
s_waitcnt vmcnt(0)
v_cmp_eq_u32 s[4:5], s9, v11
s_add_u32 s26, s26, 1
s_nop 0
s_and_b32 s24, s4, 0xfffff
s_cmp_eq_u32 s24, 0xfffff
s_cbranch_scc1 plok_227
s_cmp_lt_u32 s26, 60000
s_cbranch_scc1 pl_226
plok_227:
nfu_225:
s_barrier
s_add_u32 m0, s19, 49152
s_add_u32 s18, s16, 8192
buffer_load_dwordx4 v5, s[44:47], s16 offen sc1 lds
s_add_u32 m0, m0, 1024
s_add_u32 s16, s16, 65536
buffer_load_dwordx4 v5, s[44:47], s18 offen sc1 lds
s_add_u32 m0, s19, 114688
s_add_u32 s18, s17, 8192
buffer_load_dwordx4 v3, s[56:59], s17 offen lds
s_add_u32 m0, m0, 1024
s_add_u32 s17, s17, 65536
buffer_load_dwordx4 v3, s[56:59], s18 offen lds
s_cmp_eq_u32 s8, 0
s_cbranch_scc0 ifo_228
v_and_b32 v14, 7, v0
v_lshlrev_b32 v14, 6, v14
s_lshl_b32 s27, s100, 9
s_add_u32 s27, s27, 0x1814000
buffer_load_dword v13, v14, s[28:31], s27 offen sc1
ifo_228:
s_waitcnt vmcnt(10)
s_cmp_eq_u32 s8, 0
s_cbranch_scc0 nfu_229
s_and_b32 s24, s4, 0x1fffff
s_cmp_eq_u32 s24, 0x1fffff
s_cbranch_scc1 nfu_229
s_mov_b32 s26, 0
pl_230:
buffer_load_dword v11, v10, s[28:31], s23 offen sc1
s_waitcnt vmcnt(0)
v_cmp_eq_u32 s[4:5], s9, v11
s_add_u32 s26, s26, 1
s_nop 0
s_and_b32 s24, s4, 0x1fffff
s_cmp_eq_u32 s24, 0x1fffff
s_cbranch_scc1 plok_231
s_cmp_lt_u32 s26, 60000
s_cbranch_scc1 pl_230
plok_231:
nfu_229:
s_barrier
s_add_u32 m0, s19, 65536
s_add_u32 s18, s16, 8192
buffer_load_dwordx4 v5, s[44:47], s16 offen sc1 lds
s_add_u32 m0, m0, 1024
s_add_u32 s16, s16, 65536
buffer_load_dwordx4 v5, s[44:47], s18 offen sc1 lds
s_add_u32 m0, s19, 0
s_add_u32 s18, s17, 8192
buffer_load_dwordx4 v3, s[56:59], s17 offen lds
s_add_u32 m0, m0, 1024
s_add_u32 s17, s17, 65536
buffer_load_dwordx4 v3, s[56:59], s18 offen lds
s_waitcnt vmcnt(10)
s_cmp_eq_u32 s8, 0
s_cbranch_scc0 nfu_232
s_and_b32 s24, s4, 0x3fffff
s_cmp_eq_u32 s24, 0x3fffff
s_cbranch_scc1 nfu_232
s_mov_b32 s26, 0
pl_233:
buffer_load_dword v11, v10, s[28:31], s23 offen sc1
s_waitcnt vmcnt(0)
v_cmp_eq_u32 s[4:5], s9, v11
s_add_u32 s26, s26, 1
s_nop 0
s_and_b32 s24, s4, 0x3fffff
s_cmp_eq_u32 s24, 0x3fffff
s_cbranch_scc1 plok_234
s_cmp_lt_u32 s26, 60000
s_cbranch_scc1 pl_233
plok_234:
nfu_232:
s_barrier
s_add_u32 m0, s19, 81920
s_add_u32 s18, s16, 8192
buffer_load_dwordx4 v5, s[44:47], s16 offen sc1 lds
s_add_u32 m0, m0, 1024
s_add_u32 s16, s16, 65536
buffer_load_dwordx4 v5, s[44:47], s18 offen sc1 lds
s_add_u32 m0, s19, 16384
s_add_u32 s18, s17, 8192
buffer_load_dwordx4 v3, s[56:59], s17 offen lds
s_add_u32 m0, m0, 1024
s_add_u32 s17, s17, 65536
buffer_load_dwordx4 v3, s[56:59], s18 offen lds
s_waitcnt vmcnt(10)
s_cmp_eq_u32 s8, 0
s_cbranch_scc0 nofo_235
v_and_b32 v10, 7, v0
v_lshlrev_b32 v10, 6, v10
s_lshl_b32 s23, s100, 9
s_add_u32 s23, s23, 0x1814000
s_waitcnt vmcnt(8)
v_cmp_eq_u32 s[4:5], s9, v13
s_nop 1
s_cmp_eq_u64 s[4:5], exec
s_cbranch_scc1 nofo_235
s_mov_b32 s26, 0
pl_236:
buffer_load_dword v11, v10, s[28:31], s23 offen sc1
s_waitcnt vmcnt(0)
v_cmp_eq_u32 s[4:5], s9, v11
s_add_u32 s26, s26, 1
s_nop 0
s_cmp_eq_u64 s[4:5], exec
s_cbranch_scc1 plok_237
s_cmp_lt_u32 s26, 60000
s_cbranch_scc1 pl_236
plok_237:
nofo_235:
s_barrier
s_lshl_b32 s16, s8, 16
s_lshl_b32 s18, s80, 4
s_add_u32 s16, s16, s18
s_add_u32 s16, s16, 0x1100000
s_add_u32 m0, s19, 106496
s_add_u32 s18, s16, 32768
buffer_load_dwordx4 v5, s[28:31], s16 offen sc1 lds
s_add_u32 m0, m0, 1024
s_add_u32 s16, s16, 262144
buffer_load_dwordx4 v5, s[28:31], s18 offen sc1 lds
s_add_u32 m0, s19, 32768
s_add_u32 s18, s17, 8192
buffer_load_dwordx4 v3, s[56:59], s17 offen lds
s_add_u32 m0, m0, 1024
s_add_u32 s17, s17, 65536
buffer_load_dwordx4 v3, s[56:59], s18 offen lds
s_waitcnt vmcnt(10)
s_barrier
s_add_u32 m0, s19, 122880
s_add_u32 s18, s16, 32768
buffer_load_dwordx4 v5, s[28:31], s16 offen sc1 lds
s_add_u32 m0, m0, 1024
s_add_u32 s16, s16, 262144
buffer_load_dwordx4 v5, s[28:31], s18 offen sc1 lds
s_add_u32 m0, s19, 49152
s_add_u32 s18, s17, 8192
buffer_load_dwordx4 v3, s[56:59], s17 offen lds
s_add_u32 m0, m0, 1024
s_add_u32 s17, s17, 65536
buffer_load_dwordx4 v3, s[56:59], s18 offen lds
s_waitcnt vmcnt(10)
s_barrier
s_add_u32 m0, s19, 8192
s_add_u32 s18, s16, 32768
buffer_load_dwordx4 v5, s[28:31], s16 offen sc1 lds
s_add_u32 m0, m0, 1024
s_add_u32 s16, s16, 262144
buffer_load_dwordx4 v5, s[28:31], s18 offen sc1 lds
s_add_u32 m0, s19, 65536
s_add_u32 s18, s17, 8192
buffer_load_dwordx4 v3, s[56:59], s17 offen lds
s_add_u32 m0, m0, 1024
s_add_u32 s17, s17, 65536
buffer_load_dwordx4 v3, s[56:59], s18 offen lds
s_waitcnt vmcnt(10)
s_barrier
s_add_u32 m0, s19, 24576
s_add_u32 s18, s16, 32768
buffer_load_dwordx4 v5, s[28:31], s16 offen sc1 lds
s_add_u32 m0, m0, 1024
s_add_u32 s16, s16, 262144
buffer_load_dwordx4 v5, s[28:31], s18 offen sc1 lds
s_add_u32 m0, s19, 81920
s_add_u32 s18, s17, 8192
buffer_load_dwordx4 v3, s[56:59], s17 offen lds
s_add_u32 m0, m0, 1024
s_add_u32 s17, s17, 65536
buffer_load_dwordx4 v3, s[56:59], s18 offen lds
s_waitcnt vmcnt(10)
s_barrier
s_add_u32 m0, s19, 40960
s_add_u32 s18, s16, 32768
buffer_load_dwordx4 v5, s[28:31], s16 offen sc1 lds
s_add_u32 m0, m0, 1024
s_add_u32 s16, s16, 262144
buffer_load_dwordx4 v5, s[28:31], s18 offen sc1 lds
s_waitcnt vmcnt(8)
s_barrier
s_add_u32 m0, s19, 57344
s_add_u32 s18, s16, 32768
buffer_load_dwordx4 v5, s[28:31], s16 offen sc1 lds
s_add_u32 m0, m0, 1024
s_add_u32 s16, s16, 262144
buffer_load_dwordx4 v5, s[28:31], s18 offen sc1 lds
s_waitcnt vmcnt(6)
s_barrier
s_add_u32 m0, s19, 73728
s_add_u32 s18, s16, 32768
buffer_load_dwordx4 v5, s[28:31], s16 offen sc1 lds
s_add_u32 m0, m0, 1024
s_add_u32 s16, s16, 262144
buffer_load_dwordx4 v5, s[28:31], s18 offen sc1 lds
s_waitcnt vmcnt(4)
s_barrier
s_add_u32 m0, s19, 90112
s_add_u32 s18, s16, 32768
buffer_load_dwordx4 v5, s[28:31], s16 offen sc1 lds
s_add_u32 m0, m0, 1024
s_add_u32 s16, s16, 262144
buffer_load_dwordx4 v5, s[28:31], s18 offen sc1 lds
s_waitcnt vmcnt(4)
s_barrier
s_waitcnt vmcnt(2)
s_barrier
s_waitcnt vmcnt(0)
s_barrier
s_endpgm
gated_mix__linear_kernel_hedgehog__mixer_token_mlp__prompt_kernel_C:
s_setprio 3
s_mov_b32 s32, s60
s_mov_b32 s33, s61
s_mov_b32 s34, 0x200000
s_mov_b32 s35, 0x20000
s_mov_b32 s36, s76
s_mov_b32 s37, s77
s_mov_b32 s38, 0x400
s_mov_b32 s39, 0x20000
v_lshlrev_b32 v2, 4, v0
s_lshl_b32 s16, s12, 3
s_lshl_b32 s18, s15, 1
s_add_u32 s16, s16, s18
s_lshl_b32 s17, s16, 10
buffer_load_dwordx4 v[16:19], v2, s[32:35], s17 offen
buffer_load_dwordx4 v[20:23], v2, s[32:35], s17 offen offset:1024
buffer_load_dwordx4 v[24:27], v2, s[36:39], 0 offen
v_lshlrev_b32 v14, 2, v0
v_and_b32 v14, 63, v14
v_add_u32 v14, 159872, v14
v_mov_b32 v15, 0
ds_write_b32 v14, v15
s_waitcnt lgkmcnt(0)
s_barrier
s_load_dword s9, s[24:25], 0
s_mov_b32 s44, s74
s_mov_b32 s45, s75
s_mov_b32 s46, 0x1000
s_mov_b32 s47, 0x20000
s_mov_b32 s48, s78
s_mov_b32 s49, s79
s_mov_b32 s50, 0x200000
s_mov_b32 s51, 0x20000
v_mov_b32 v10, 0x3f803f80
v_mov_b32 v11, 0x3f803f80
v_mov_b32 v12, 0x3f803f80
v_mov_b32 v13, 0x3f803f80
s_lshl_b32 s18, s13, 10
s_add_u32 s18, s18, 157824
v_add_u32 v14, s18, v2
ds_write_b128 v14, v[10:13]
s_waitcnt vmcnt(0)
v_lshlrev_b32 v32, 16, v16
v_and_b32 v33, 0xffff0000, v16
v_lshlrev_b32 v34, 16, v17
v_and_b32 v35, 0xffff0000, v17
v_lshlrev_b32 v36, 16, v18
v_and_b32 v37, 0xffff0000, v18
v_lshlrev_b32 v38, 16, v19
v_and_b32 v39, 0xffff0000, v19
v_lshlrev_b32 v40, 16, v20
v_and_b32 v41, 0xffff0000, v20
v_lshlrev_b32 v42, 16, v21
v_and_b32 v43, 0xffff0000, v21
v_lshlrev_b32 v44, 16, v22
v_and_b32 v45, 0xffff0000, v22
v_lshlrev_b32 v46, 16, v23
v_and_b32 v47, 0xffff0000, v23
v_mov_b32 v50, 0
v_mov_b32 v51, 0
v_dot2_f32_bf16 v50, v16, v24, v50
v_dot2_f32_bf16 v51, v20, v24, v51
v_dot2_f32_bf16 v50, v17, v25, v50
v_dot2_f32_bf16 v51, v21, v25, v51
v_dot2_f32_bf16 v50, v18, v26, v50
v_dot2_f32_bf16 v51, v22, v26, v51
v_dot2_f32_bf16 v50, v19, v27, v50
v_dot2_f32_bf16 v51, v23, v27, v51
v_add_f32 v48, v32, v33
v_add_f32 v49, v40, v41
v_add_f32 v48, v48, v34
v_add_f32 v49, v49, v42
v_add_f32 v48, v48, v35
v_add_f32 v49, v49, v43
v_add_f32 v48, v48, v36
v_add_f32 v49, v49, v44
v_add_f32 v48, v48, v37
v_add_f32 v49, v49, v45
v_add_f32 v48, v48, v38
v_add_f32 v49, v49, v46
v_add_f32 v48, v48, v39
v_add_f32 v49, v49, v47
s_nop 1
v_add_f32_dpp v48, v48, v48 row_shr:1 row_mask:0xf bank_mask:0xf bound_ctrl:0
v_add_f32_dpp v49, v49, v49 row_shr:1 row_mask:0xf bank_mask:0xf bound_ctrl:0
v_add_f32_dpp v50, v50, v50 row_shr:1 row_mask:0xf bank_mask:0xf bound_ctrl:0
v_add_f32_dpp v51, v51, v51 row_shr:1 row_mask:0xf bank_mask:0xf bound_ctrl:0
v_add_f32_dpp v48, v48, v48 row_shr:2 row_mask:0xf bank_mask:0xf bound_ctrl:0
v_add_f32_dpp v49, v49, v49 row_shr:2 row_mask:0xf bank_mask:0xf bound_ctrl:0
v_add_f32_dpp v50, v50, v50 row_shr:2 row_mask:0xf bank_mask:0xf bound_ctrl:0
v_add_f32_dpp v51, v51, v51 row_shr:2 row_mask:0xf bank_mask:0xf bound_ctrl:0
v_add_f32_dpp v48, v48, v48 row_shr:4 row_mask:0xf bank_mask:0xf bound_ctrl:0
v_add_f32_dpp v49, v49, v49 row_shr:4 row_mask:0xf bank_mask:0xf bound_ctrl:0
v_add_f32_dpp v50, v50, v50 row_shr:4 row_mask:0xf bank_mask:0xf bound_ctrl:0
v_add_f32_dpp v51, v51, v51 row_shr:4 row_mask:0xf bank_mask:0xf bound_ctrl:0
v_add_f32_dpp v48, v48, v48 row_shr:8 row_mask:0xf bank_mask:0xf bound_ctrl:0
v_add_f32_dpp v49, v49, v49 row_shr:8 row_mask:0xf bank_mask:0xf bound_ctrl:0
v_add_f32_dpp v50, v50, v50 row_shr:8 row_mask:0xf bank_mask:0xf bound_ctrl:0
v_add_f32_dpp v51, v51, v51 row_shr:8 row_mask:0xf bank_mask:0xf bound_ctrl:0
v_add_f32_dpp v48, v48, v48 row_bcast:15 row_mask:0xa bank_mask:0xf
v_add_f32_dpp v49, v49, v49 row_bcast:15 row_mask:0xa bank_mask:0xf
v_add_f32_dpp v50, v50, v50 row_bcast:15 row_mask:0xa bank_mask:0xf
v_add_f32_dpp v51, v51, v51 row_bcast:15 row_mask:0xa bank_mask:0xf
v_add_f32_dpp v48, v48, v48 row_bcast:31 row_mask:0xc bank_mask:0xf
v_add_f32_dpp v49, v49, v49 row_bcast:31 row_mask:0xc bank_mask:0xf
v_add_f32_dpp v50, v50, v50 row_bcast:31 row_mask:0xc bank_mask:0xf
v_add_f32_dpp v51, v51, v51 row_bcast:31 row_mask:0xc bank_mask:0xf
s_nop 1
v_readlane_b32 s4, v48, 63
v_readlane_b32 s5, v49, 63
v_readlane_b32 s6, v50, 63
v_readlane_b32 s24, v51, 63
s_nop 1
v_mov_b32 v48, s4
v_mov_b32 v50, s6
v_mov_b32 v49, s5
v_mov_b32 v51, s24
v_mul_f32 v48, 0x3b000000, v48
v_mul_f32 v50, 0xbfb8aa3b, v50
v_mul_f32 v49, 0x3b000000, v49
v_mul_f32 v51, 0xbfb8aa3b, v51
v_sub_f32 v32, v32, v48
v_sub_f32 v33, v33, v48
v_sub_f32 v34, v34, v48
v_sub_f32 v35, v35, v48
v_sub_f32 v36, v36, v48
v_sub_f32 v37, v37, v48
v_sub_f32 v38, v38, v48
v_sub_f32 v39, v39, v48
v_exp_f32 v50, v50
v_sub_f32 v40, v40, v49
v_sub_f32 v41, v41, v49
v_sub_f32 v42, v42, v49
v_sub_f32 v43, v43, v49
v_sub_f32 v44, v44, v49
v_sub_f32 v45, v45, v49
v_sub_f32 v46, v46, v49
v_sub_f32 v47, v47, v49
v_exp_f32 v51, v51
v_mul_f32 v48, v32, v32
v_mul_f32 v49, v40, v40
v_fmac_f32 v48, v33, v33
v_fmac_f32 v49, v41, v41
v_fmac_f32 v48, v34, v34
v_fmac_f32 v49, v42, v42
v_fmac_f32 v48, v35, v35
v_fmac_f32 v49, v43, v43
v_fmac_f32 v48, v36, v36
v_fmac_f32 v49, v44, v44
v_fmac_f32 v48, v37, v37
v_fmac_f32 v49, v45, v45
v_fmac_f32 v48, v38, v38
v_fmac_f32 v49, v46, v46
v_fmac_f32 v48, v39, v39
v_fmac_f32 v49, v47, v47
v_add_f32 v50, 1.0, v50
v_add_f32 v51, 1.0, v51
v_rcp_f32 v50, v50
v_rcp_f32 v51, v51
s_nop 1
v_add_f32_dpp v48, v48, v48 row_shr:1 row_mask:0xf bank_mask:0xf bound_ctrl:0
v_add_f32_dpp v49, v49, v49 row_shr:1 row_mask:0xf bank_mask:0xf bound_ctrl:0
s_nop 0
v_add_f32_dpp v48, v48, v48 row_shr:2 row_mask:0xf bank_mask:0xf bound_ctrl:0
v_add_f32_dpp v49, v49, v49 row_shr:2 row_mask:0xf bank_mask:0xf bound_ctrl:0
s_nop 0
v_add_f32_dpp v48, v48, v48 row_shr:4 row_mask:0xf bank_mask:0xf bound_ctrl:0
v_add_f32_dpp v49, v49, v49 row_shr:4 row_mask:0xf bank_mask:0xf bound_ctrl:0
s_nop 0
v_add_f32_dpp v48, v48, v48 row_shr:8 row_mask:0xf bank_mask:0xf bound_ctrl:0
v_add_f32_dpp v49, v49, v49 row_shr:8 row_mask:0xf bank_mask:0xf bound_ctrl:0
s_nop 0
v_add_f32_dpp v48, v48, v48 row_bcast:15 row_mask:0xa bank_mask:0xf
v_add_f32_dpp v49, v49, v49 row_bcast:15 row_mask:0xa bank_mask:0xf
s_nop 0
v_add_f32_dpp v48, v48, v48 row_bcast:31 row_mask:0xc bank_mask:0xf
v_add_f32_dpp v49, v49, v49 row_bcast:31 row_mask:0xc bank_mask:0xf
s_nop 1
v_readlane_b32 s4, v48, 63
v_readlane_b32 s5, v49, 63
s_nop 1
v_mov_b32 v48, s4
v_mov_b32 v49, s5
v_mul_f32 v48, 0x3b000000, v48
v_mul_f32 v49, 0x3b000000, v49
v_add_f32 v48, 0x3727c5ac, v48
v_add_f32 v49, 0x3727c5ac, v49
v_rsq_f32 v48, v48
v_rsq_f32 v49, v49
s_nop 0
v_mul_f32 v32, v32, v48
v_mul_f32 v33, v33, v48
v_mul_f32 v34, v34, v48
v_mul_f32 v35, v35, v48
v_mul_f32 v36, v36, v48
v_mul_f32 v37, v37, v48
v_mul_f32 v38, v38, v48
v_mul_f32 v39, v39, v48
v_cvt_pk_bf16_f32 v16, v32, v33
v_cvt_pk_bf16_f32 v17, v34, v35
v_cvt_pk_bf16_f32 v18, v36, v37
v_cvt_pk_bf16_f32 v19, v38, v39
v_mul_f32 v40, v40, v49
v_mul_f32 v41, v41, v49
v_mul_f32 v42, v42, v49
v_mul_f32 v43, v43, v49
v_mul_f32 v44, v44, v49
v_mul_f32 v45, v45, v49
v_mul_f32 v46, v46, v49
v_mul_f32 v47, v47, v49
v_cvt_pk_bf16_f32 v20, v40, v41
v_cvt_pk_bf16_f32 v21, v42, v43
v_cvt_pk_bf16_f32 v22, v44, v45
v_cvt_pk_bf16_f32 v23, v46, v47
s_mul_i32 s18, s15, 2176
s_add_u32 s18, s18, 120832
v_add_u32 v3, s18, v2
ds_write_b128 v3, v[16:19]
ds_write_b128 v3, v[20:23] offset:1088
s_lshl_b32 s16, s16, 2
s_add_u32 s16, s16, 0x780000
v_mov_b32 v3, 0
s_mov_b64 exec, 1
buffer_store_dword v50, v3, s[28:31], s16 offen sc1
buffer_store_dword v51, v3, s[28:31], s16 offen offset:4 sc1
s_mov_b64 exec, -1
s_waitcnt lgkmcnt(0)
v_mov_b32 v14, 159900
v_mov_b32 v15, 1
s_mov_b64 exec, 1
ds_add_u32 v14, v15
s_mov_b64 exec, -1
v_mov_b32 v14, 159900
s_mov_b32 s25, 0
sw_238:
ds_read_b32 v15, v14
s_add_u32 s25, s25, 1
s_waitcnt lgkmcnt(0)
v_readfirstlane_b32 s24, v15
s_cmp_ge_u32 s24, 4
s_cbranch_scc1 swd_239
s_cmp_lt_u32 s25, 4000000
s_cbranch_scc1 sw_238
swd_239:
s_mul_i32 s9, s9, 0x9E3779B1
s_add_u32 s9, s9, 0x7F4A7C15
v_lshrrev_b32 v4, 4, v0
v_bfe_u32 v5, v0, 2, 2
v_and_b32 v6, 3, v0
v_lshlrev_b32 v6, 3, v6
v_lshl_add_u32 v6, v4, 5, v6
v_mul_u32_u24 v7, 1088, v5
v_add_u32 v7, v7, v6
s_lshl_b32 s18, s15, 8
s_add_u32 s18, s18, 120832
v_add_u32 v7, s18, v7
ds_read_b64_tr_b16 v[16:17], v7 offset:0
ds_read_b64_tr_b16 v[18:19], v7 offset:4352
ds_read_b64_tr_b16 v[20:21], v7 offset:128
ds_read_b64_tr_b16 v[22:23], v7 offset:4480
s_lshl_b32 s16, s12, 13
s_lshl_b32 s18, s15, 11
s_add_u32 s16, s16, s18
s_add_u32 s16, s16, 0x0
s_waitcnt lgkmcnt(0)
buffer_store_dwordx4 v[16:19], v2, s[28:31], s16 offen sc1
buffer_store_dwordx4 v[20:23], v2, s[28:31], s16 offen offset:1024 sc1
v_and_b32 v14, 31, v0
s_lshl_b32 s18, s14, 5
v_add_u32 v14, s18, v14
v_lshrrev_b32 v15, 5, v0
v_bfe_u32 v3, v14, 1, 3
v_xor_b32 v3, v3, v15
v_lshlrev_b32 v3, 4, v3
v_lshl_add_u32 v4, v14, 7, v3
v_xor_b32 v5, 32, v4
v_xor_b32 v6, 64, v4
v_xor_b32 v7, 0x60, v4
v_add_u32 v8, 0x10000, v4
v_add_u32 v9, 0x10000, v5
v_add_u32 v10, 0x10000, v6
v_add_u32 v11, 0x10000, v7
v_bfe_u32 v14, v0, 2, 2
v_lshl_add_u32 v3, v15, 3, v14
v_lshlrev_b32 v3, 7, v3
v_bfe_u32 v15, v0, 4, 1
v_lshl_add_u32 v3, v15, 5, v3
v_and_b32 v15, 3, v0
v_lshl_add_u32 v3, v15, 3, v3
v_lshrrev_b32 v14, 1, v14
v_xor_b32 v14, s13, v14
v_lshl_add_u32 v3, v14, 6, v3
v_add_u32 v12, 8192, v3
v_add_u32 v13, 0x12000, v3
s_mov_b32 s4, 0
s_barrier
ds_read_b128 v[64:67], v4 offset:0
ds_read_b64_tr_b16 v[68:69], v12 offset:0
ds_read_b64_tr_b16 v[70:71], v12 offset:512
ds_read_b64_tr_b16 v[72:73], v12 offset:8192
ds_read_b64_tr_b16 v[74:75], v12 offset:8704
ds_read_b64_tr_b16 v[76:77], v12 offset:16384
ds_read_b64_tr_b16 v[78:79], v12 offset:16896
ds_read_b128 v[80:83], v5 offset:0
ds_read_b64_tr_b16 v[84:85], v12 offset:2048
ds_read_b64_tr_b16 v[86:87], v12 offset:2560
ds_read_b64_tr_b16 v[88:89], v12 offset:10240
ds_read_b64_tr_b16 v[90:91], v12 offset:10752
ds_read_b64_tr_b16 v[92:93], v12 offset:18432
ds_read_b64_tr_b16 v[94:95], v12 offset:18944
ds_read_b128 v[96:99], v6 offset:0
ds_read_b64_tr_b16 v[100:101], v12 offset:4096
ds_read_b64_tr_b16 v[102:103], v12 offset:4608
ds_read_b64_tr_b16 v[104:105], v12 offset:12288
ds_read_b64_tr_b16 v[106:107], v12 offset:12800
ds_read_b64_tr_b16 v[108:109], v12 offset:20480
ds_read_b64_tr_b16 v[110:111], v12 offset:20992
ds_read_b128 v[112:115], v7 offset:0
ds_read_b64_tr_b16 v[116:117], v12 offset:6144
ds_read_b64_tr_b16 v[118:119], v12 offset:6656
ds_read_b64_tr_b16 v[120:121], v12 offset:14336
ds_read_b64_tr_b16 v[122:123], v12 offset:14848
ds_read_b64_tr_b16 v[124:125], v12 offset:22528
ds_read_b64_tr_b16 v[126:127], v12 offset:23040
s_waitcnt lgkmcnt(0)
s_cmp_eq_u32 s4, 2
s_cbranch_scc1 fh2_241
s_cmp_eq_u32 s4, 1
s_cbranch_scc0 fh1_240
v_readfirstlane_b32 s24, v3
s_mov_b32 s4, 2
s_cmp_eq_u32 s24, 5
s_cbranch_scc0 fh2_241
s_lshl_b32 s24, s12, 6
s_add_u32 s24, s24, 0x1801000
v_mov_b32 v14, s9
v_mov_b32 v15, 0
s_mov_b64 exec, 1
buffer_store_dword v14, v15, s[28:31], s24 offen sc1
s_mov_b64 exec, -1
s_branch fh2_241
fh1_240:
s_getreg_b32 s24, hwreg(HW_REG_IB_STS, 0, 4)
s_cmp_eq_u32 s24, 0
s_cbranch_scc0 fh2_241
v_mov_b32 v14, 159908
v_mov_b32 v15, 1
s_mov_b64 exec, 1
ds_add_rtn_u32 v3, v14, v15
s_mov_b64 exec, -1
s_mov_b32 s4, 1
fh2_241:
s_barrier
v_mfma_f32_32x32x16_bf16 v[192:207], v[68:71], v[64:67], 0
ds_read_b128 v[128:131], v4 offset:32768
ds_read_b64_tr_b16 v[132:133], v12 offset:32768
ds_read_b64_tr_b16 v[134:135], v12 offset:33280
v_mfma_f32_32x32x16_bf16 v[208:223], v[72:75], v[64:67], 0
ds_read_b64_tr_b16 v[136:137], v12 offset:40960
ds_read_b64_tr_b16 v[138:139], v12 offset:41472
v_mfma_f32_32x32x16_bf16 v[224:239], v[76:79], v[64:67], 0
ds_read_b64_tr_b16 v[140:141], v12 offset:49152
ds_read_b64_tr_b16 v[142:143], v12 offset:49664
v_mfma_f32_32x32x16_bf16 v[192:207], v[84:87], v[80:83], v[192:207]
ds_read_b128 v[144:147], v5 offset:32768
ds_read_b64_tr_b16 v[148:149], v12 offset:34816
ds_read_b64_tr_b16 v[150:151], v12 offset:35328
v_mfma_f32_32x32x16_bf16 v[208:223], v[88:91], v[80:83], v[208:223]
ds_read_b64_tr_b16 v[152:153], v12 offset:43008
ds_read_b64_tr_b16 v[154:155], v12 offset:43520
v_mfma_f32_32x32x16_bf16 v[224:239], v[92:95], v[80:83], v[224:239]
ds_read_b64_tr_b16 v[156:157], v12 offset:51200
ds_read_b64_tr_b16 v[158:159], v12 offset:51712
v_mfma_f32_32x32x16_bf16 v[192:207], v[100:103], v[96:99], v[192:207]
ds_read_b128 v[160:163], v6 offset:32768
ds_read_b64_tr_b16 v[164:165], v12 offset:36864
ds_read_b64_tr_b16 v[166:167], v12 offset:37376
v_mfma_f32_32x32x16_bf16 v[208:223], v[104:107], v[96:99], v[208:223]
ds_read_b64_tr_b16 v[168:169], v12 offset:45056
ds_read_b64_tr_b16 v[170:171], v12 offset:45568
v_mfma_f32_32x32x16_bf16 v[224:239], v[108:111], v[96:99], v[224:239]
ds_read_b64_tr_b16 v[172:173], v12 offset:53248
ds_read_b64_tr_b16 v[174:175], v12 offset:53760
v_mfma_f32_32x32x16_bf16 v[192:207], v[116:119], v[112:115], v[192:207]
ds_read_b128 v[176:179], v7 offset:32768
ds_read_b64_tr_b16 v[180:181], v12 offset:38912
ds_read_b64_tr_b16 v[182:183], v12 offset:39424
v_mfma_f32_32x32x16_bf16 v[208:223], v[120:123], v[112:115], v[208:223]
ds_read_b64_tr_b16 v[184:185], v12 offset:47104
ds_read_b64_tr_b16 v[186:187], v12 offset:47616
v_mfma_f32_32x32x16_bf16 v[224:239], v[124:127], v[112:115], v[224:239]
ds_read_b64_tr_b16 v[188:189], v12 offset:55296
ds_read_b64_tr_b16 v[190:191], v12 offset:55808
s_waitcnt lgkmcnt(0)
s_cmp_eq_u32 s4, 2
s_cbranch_scc1 fh2_243
s_cmp_eq_u32 s4, 1
s_cbranch_scc0 fh1_242
v_readfirstlane_b32 s24, v3
s_mov_b32 s4, 2
s_cmp_eq_u32 s24, 5
s_cbranch_scc0 fh2_243
s_lshl_b32 s24, s12, 6
s_add_u32 s24, s24, 0x1801000
v_mov_b32 v14, s9
v_mov_b32 v15, 0
s_mov_b64 exec, 1
buffer_store_dword v14, v15, s[28:31], s24 offen sc1
s_mov_b64 exec, -1
s_branch fh2_243
fh1_242:
s_getreg_b32 s24, hwreg(HW_REG_IB_STS, 0, 4)
s_cmp_eq_u32 s24, 0
s_cbranch_scc0 fh2_243
v_mov_b32 v14, 159908
v_mov_b32 v15, 1
s_mov_b64 exec, 1
ds_add_rtn_u32 v3, v14, v15
s_mov_b64 exec, -1
s_mov_b32 s4, 1
fh2_243:
s_barrier
v_mfma_f32_32x32x16_bf16 v[192:207], v[132:135], v[128:131], v[192:207]
ds_read_b128 v[64:67], v8 offset:0
ds_read_b64_tr_b16 v[68:69], v13 offset:0
ds_read_b64_tr_b16 v[70:71], v13 offset:512
v_mfma_f32_32x32x16_bf16 v[208:223], v[136:139], v[128:131], v[208:223]
ds_read_b64_tr_b16 v[72:73], v13 offset:8192
ds_read_b64_tr_b16 v[74:75], v13 offset:8704
v_mfma_f32_32x32x16_bf16 v[224:239], v[140:143], v[128:131], v[224:239]
ds_read_b64_tr_b16 v[76:77], v13 offset:16384
ds_read_b64_tr_b16 v[78:79], v13 offset:16896
v_mfma_f32_32x32x16_bf16 v[192:207], v[148:151], v[144:147], v[192:207]
ds_read_b128 v[80:83], v9 offset:0
ds_read_b64_tr_b16 v[84:85], v13 offset:2048
ds_read_b64_tr_b16 v[86:87], v13 offset:2560
v_mfma_f32_32x32x16_bf16 v[208:223], v[152:155], v[144:147], v[208:223]
ds_read_b64_tr_b16 v[88:89], v13 offset:10240
ds_read_b64_tr_b16 v[90:91], v13 offset:10752
v_mfma_f32_32x32x16_bf16 v[224:239], v[156:159], v[144:147], v[224:239]
ds_read_b64_tr_b16 v[92:93], v13 offset:18432
ds_read_b64_tr_b16 v[94:95], v13 offset:18944
v_mfma_f32_32x32x16_bf16 v[192:207], v[164:167], v[160:163], v[192:207]
ds_read_b128 v[96:99], v10 offset:0
ds_read_b64_tr_b16 v[100:101], v13 offset:4096
ds_read_b64_tr_b16 v[102:103], v13 offset:4608
v_mfma_f32_32x32x16_bf16 v[208:223], v[168:171], v[160:163], v[208:223]
ds_read_b64_tr_b16 v[104:105], v13 offset:12288
ds_read_b64_tr_b16 v[106:107], v13 offset:12800
v_mfma_f32_32x32x16_bf16 v[224:239], v[172:175], v[160:163], v[224:239]
ds_read_b64_tr_b16 v[108:109], v13 offset:20480
ds_read_b64_tr_b16 v[110:111], v13 offset:20992
v_mfma_f32_32x32x16_bf16 v[192:207], v[180:183], v[176:179], v[192:207]
ds_read_b128 v[112:115], v11 offset:0
ds_read_b64_tr_b16 v[116:117], v13 offset:6144
ds_read_b64_tr_b16 v[118:119], v13 offset:6656
v_mfma_f32_32x32x16_bf16 v[208:223], v[184:187], v[176:179], v[208:223]
ds_read_b64_tr_b16 v[120:121], v13 offset:14336
ds_read_b64_tr_b16 v[122:123], v13 offset:14848
v_mfma_f32_32x32x16_bf16 v[224:239], v[188:191], v[176:179], v[224:239]
ds_read_b64_tr_b16 v[124:125], v13 offset:22528
ds_read_b64_tr_b16 v[126:127], v13 offset:23040
s_waitcnt lgkmcnt(0)
s_cmp_eq_u32 s4, 2
s_cbranch_scc1 fh2_245
s_cmp_eq_u32 s4, 1
s_cbranch_scc0 fh1_244
v_readfirstlane_b32 s24, v3
s_mov_b32 s4, 2
s_cmp_eq_u32 s24, 5
s_cbranch_scc0 fh2_245
s_lshl_b32 s24, s12, 6
s_add_u32 s24, s24, 0x1801000
v_mov_b32 v14, s9
v_mov_b32 v15, 0
s_mov_b64 exec, 1
buffer_store_dword v14, v15, s[28:31], s24 offen sc1
s_mov_b64 exec, -1
s_branch fh2_245
fh1_244:
s_getreg_b32 s24, hwreg(HW_REG_IB_STS, 0, 4)
s_cmp_eq_u32 s24, 0
s_cbranch_scc0 fh2_245
v_mov_b32 v14, 159908
v_mov_b32 v15, 1
s_mov_b64 exec, 1
ds_add_rtn_u32 v3, v14, v15
s_mov_b64 exec, -1
s_mov_b32 s4, 1
fh2_245:
s_barrier
v_mfma_f32_32x32x16_bf16 v[192:207], v[68:71], v[64:67], v[192:207]
ds_read_b128 v[128:131], v8 offset:32768
ds_read_b64_tr_b16 v[132:133], v13 offset:32768
ds_read_b64_tr_b16 v[134:135], v13 offset:33280
v_mfma_f32_32x32x16_bf16 v[208:223], v[72:75], v[64:67], v[208:223]
ds_read_b64_tr_b16 v[136:137], v13 offset:40960
ds_read_b64_tr_b16 v[138:139], v13 offset:41472
v_mfma_f32_32x32x16_bf16 v[224:239], v[76:79], v[64:67], v[224:239]
ds_read_b64_tr_b16 v[140:141], v13 offset:49152
ds_read_b64_tr_b16 v[142:143], v13 offset:49664
v_mfma_f32_32x32x16_bf16 v[192:207], v[84:87], v[80:83], v[192:207]
ds_read_b128 v[144:147], v9 offset:32768
ds_read_b64_tr_b16 v[148:149], v13 offset:34816
ds_read_b64_tr_b16 v[150:151], v13 offset:35328
v_mfma_f32_32x32x16_bf16 v[208:223], v[88:91], v[80:83], v[208:223]
ds_read_b64_tr_b16 v[152:153], v13 offset:43008
ds_read_b64_tr_b16 v[154:155], v13 offset:43520
v_mfma_f32_32x32x16_bf16 v[224:239], v[92:95], v[80:83], v[224:239]
ds_read_b64_tr_b16 v[156:157], v13 offset:51200
ds_read_b64_tr_b16 v[158:159], v13 offset:51712
v_mfma_f32_32x32x16_bf16 v[192:207], v[100:103], v[96:99], v[192:207]
ds_read_b128 v[160:163], v10 offset:32768
ds_read_b64_tr_b16 v[164:165], v13 offset:36864
ds_read_b64_tr_b16 v[166:167], v13 offset:37376
v_mfma_f32_32x32x16_bf16 v[208:223], v[104:107], v[96:99], v[208:223]
ds_read_b64_tr_b16 v[168:169], v13 offset:45056
ds_read_b64_tr_b16 v[170:171], v13 offset:45568
v_mfma_f32_32x32x16_bf16 v[224:239], v[108:111], v[96:99], v[224:239]
ds_read_b64_tr_b16 v[172:173], v13 offset:53248
ds_read_b64_tr_b16 v[174:175], v13 offset:53760
v_mfma_f32_32x32x16_bf16 v[192:207], v[116:119], v[112:115], v[192:207]
ds_read_b128 v[176:179], v11 offset:32768
ds_read_b64_tr_b16 v[180:181], v13 offset:38912
ds_read_b64_tr_b16 v[182:183], v13 offset:39424
v_mfma_f32_32x32x16_bf16 v[208:223], v[120:123], v[112:115], v[208:223]
ds_read_b64_tr_b16 v[184:185], v13 offset:47104
ds_read_b64_tr_b16 v[186:187], v13 offset:47616
v_mfma_f32_32x32x16_bf16 v[224:239], v[124:127], v[112:115], v[224:239]
ds_read_b64_tr_b16 v[188:189], v13 offset:55296
ds_read_b64_tr_b16 v[190:191], v13 offset:55808
s_waitcnt lgkmcnt(0)
s_cmp_eq_u32 s4, 2
s_cbranch_scc1 fh2_247
s_cmp_eq_u32 s4, 1
s_cbranch_scc0 fh1_246
v_readfirstlane_b32 s24, v3
s_mov_b32 s4, 2
s_cmp_eq_u32 s24, 5
s_cbranch_scc0 fh2_247
s_lshl_b32 s24, s12, 6
s_add_u32 s24, s24, 0x1801000
v_mov_b32 v14, s9
v_mov_b32 v15, 0
s_mov_b64 exec, 1
buffer_store_dword v14, v15, s[28:31], s24 offen sc1
s_mov_b64 exec, -1
s_branch fh2_247
fh1_246:
s_getreg_b32 s24, hwreg(HW_REG_IB_STS, 0, 4)
s_cmp_eq_u32 s24, 0
s_cbranch_scc0 fh2_247
v_mov_b32 v14, 159908
v_mov_b32 v15, 1
s_mov_b64 exec, 1
ds_add_rtn_u32 v3, v14, v15
s_mov_b64 exec, -1
s_mov_b32 s4, 1
fh2_247:
s_barrier
v_mfma_f32_32x32x16_bf16 v[192:207], v[132:135], v[128:131], v[192:207]
ds_read_b128 v[64:67], v4 offset:0
ds_read_b64_tr_b16 v[68:69], v12 offset:0
ds_read_b64_tr_b16 v[70:71], v12 offset:512
v_mfma_f32_32x32x16_bf16 v[208:223], v[136:139], v[128:131], v[208:223]
ds_read_b64_tr_b16 v[72:73], v12 offset:8192
ds_read_b64_tr_b16 v[74:75], v12 offset:8704
v_mfma_f32_32x32x16_bf16 v[224:239], v[140:143], v[128:131], v[224:239]
ds_read_b64_tr_b16 v[76:77], v12 offset:16384
ds_read_b64_tr_b16 v[78:79], v12 offset:16896
v_mfma_f32_32x32x16_bf16 v[192:207], v[148:151], v[144:147], v[192:207]
ds_read_b128 v[80:83], v5 offset:0
ds_read_b64_tr_b16 v[84:85], v12 offset:2048
ds_read_b64_tr_b16 v[86:87], v12 offset:2560
v_mfma_f32_32x32x16_bf16 v[208:223], v[152:155], v[144:147], v[208:223]
ds_read_b64_tr_b16 v[88:89], v12 offset:10240
ds_read_b64_tr_b16 v[90:91], v12 offset:10752
v_mfma_f32_32x32x16_bf16 v[224:239], v[156:159], v[144:147], v[224:239]
ds_read_b64_tr_b16 v[92:93], v12 offset:18432
ds_read_b64_tr_b16 v[94:95], v12 offset:18944
v_mfma_f32_32x32x16_bf16 v[192:207], v[164:167], v[160:163], v[192:207]
ds_read_b128 v[96:99], v6 offset:0
ds_read_b64_tr_b16 v[100:101], v12 offset:4096
ds_read_b64_tr_b16 v[102:103], v12 offset:4608
v_mfma_f32_32x32x16_bf16 v[208:223], v[168:171], v[160:163], v[208:223]
ds_read_b64_tr_b16 v[104:105], v12 offset:12288
ds_read_b64_tr_b16 v[106:107], v12 offset:12800
v_mfma_f32_32x32x16_bf16 v[224:239], v[172:175], v[160:163], v[224:239]
ds_read_b64_tr_b16 v[108:109], v12 offset:20480
ds_read_b64_tr_b16 v[110:111], v12 offset:20992
v_mfma_f32_32x32x16_bf16 v[192:207], v[180:183], v[176:179], v[192:207]
ds_read_b128 v[112:115], v7 offset:0
ds_read_b64_tr_b16 v[116:117], v12 offset:6144
ds_read_b64_tr_b16 v[118:119], v12 offset:6656
v_mfma_f32_32x32x16_bf16 v[208:223], v[184:187], v[176:179], v[208:223]
ds_read_b64_tr_b16 v[120:121], v12 offset:14336
ds_read_b64_tr_b16 v[122:123], v12 offset:14848
v_mfma_f32_32x32x16_bf16 v[224:239], v[188:191], v[176:179], v[224:239]
ds_read_b64_tr_b16 v[124:125], v12 offset:22528
ds_read_b64_tr_b16 v[126:127], v12 offset:23040
s_waitcnt lgkmcnt(0)
s_cmp_eq_u32 s4, 2
s_cbranch_scc1 fh2_249
s_cmp_eq_u32 s4, 1
s_cbranch_scc0 fh1_248
v_readfirstlane_b32 s24, v3
s_mov_b32 s4, 2
s_cmp_eq_u32 s24, 5
s_cbranch_scc0 fh2_249
s_lshl_b32 s24, s12, 6
s_add_u32 s24, s24, 0x1801000
v_mov_b32 v14, s9
v_mov_b32 v15, 0
s_mov_b64 exec, 1
buffer_store_dword v14, v15, s[28:31], s24 offen sc1
s_mov_b64 exec, -1
s_branch fh2_249
fh1_248:
s_getreg_b32 s24, hwreg(HW_REG_IB_STS, 0, 4)
s_cmp_eq_u32 s24, 0
s_cbranch_scc0 fh2_249
v_mov_b32 v14, 159908
v_mov_b32 v15, 1
s_mov_b64 exec, 1
ds_add_rtn_u32 v3, v14, v15
s_mov_b64 exec, -1
s_mov_b32 s4, 1
fh2_249:
s_barrier
v_mfma_f32_32x32x16_bf16 v[192:207], v[68:71], v[64:67], v[192:207]
ds_read_b128 v[128:131], v4 offset:32768
ds_read_b64_tr_b16 v[132:133], v12 offset:32768
ds_read_b64_tr_b16 v[134:135], v12 offset:33280
v_mfma_f32_32x32x16_bf16 v[208:223], v[72:75], v[64:67], v[208:223]
ds_read_b64_tr_b16 v[136:137], v12 offset:40960
ds_read_b64_tr_b16 v[138:139], v12 offset:41472
v_mfma_f32_32x32x16_bf16 v[224:239], v[76:79], v[64:67], v[224:239]
ds_read_b64_tr_b16 v[140:141], v12 offset:49152
ds_read_b64_tr_b16 v[142:143], v12 offset:49664
v_mfma_f32_32x32x16_bf16 v[192:207], v[84:87], v[80:83], v[192:207]
ds_read_b128 v[144:147], v5 offset:32768
ds_read_b64_tr_b16 v[148:149], v12 offset:34816
ds_read_b64_tr_b16 v[150:151], v12 offset:35328
v_mfma_f32_32x32x16_bf16 v[208:223], v[88:91], v[80:83], v[208:223]
ds_read_b64_tr_b16 v[152:153], v12 offset:43008
ds_read_b64_tr_b16 v[154:155], v12 offset:43520
v_mfma_f32_32x32x16_bf16 v[224:239], v[92:95], v[80:83], v[224:239]
ds_read_b64_tr_b16 v[156:157], v12 offset:51200
ds_read_b64_tr_b16 v[158:159], v12 offset:51712
v_mfma_f32_32x32x16_bf16 v[192:207], v[100:103], v[96:99], v[192:207]
ds_read_b128 v[160:163], v6 offset:32768
ds_read_b64_tr_b16 v[164:165], v12 offset:36864
ds_read_b64_tr_b16 v[166:167], v12 offset:37376
v_mfma_f32_32x32x16_bf16 v[208:223], v[104:107], v[96:99], v[208:223]
ds_read_b64_tr_b16 v[168:169], v12 offset:45056
ds_read_b64_tr_b16 v[170:171], v12 offset:45568
v_mfma_f32_32x32x16_bf16 v[224:239], v[108:111], v[96:99], v[224:239]
ds_read_b64_tr_b16 v[172:173], v12 offset:53248
ds_read_b64_tr_b16 v[174:175], v12 offset:53760
v_mfma_f32_32x32x16_bf16 v[192:207], v[116:119], v[112:115], v[192:207]
ds_read_b128 v[176:179], v7 offset:32768
ds_read_b64_tr_b16 v[180:181], v12 offset:38912
ds_read_b64_tr_b16 v[182:183], v12 offset:39424
v_mfma_f32_32x32x16_bf16 v[208:223], v[120:123], v[112:115], v[208:223]
ds_read_b64_tr_b16 v[184:185], v12 offset:47104
ds_read_b64_tr_b16 v[186:187], v12 offset:47616
v_mfma_f32_32x32x16_bf16 v[224:239], v[124:127], v[112:115], v[224:239]
ds_read_b64_tr_b16 v[188:189], v12 offset:55296
ds_read_b64_tr_b16 v[190:191], v12 offset:55808
s_waitcnt lgkmcnt(0)
s_cmp_eq_u32 s4, 2
s_cbranch_scc1 fh2_251
s_cmp_eq_u32 s4, 1
s_cbranch_scc0 fh1_250
v_readfirstlane_b32 s24, v3
s_mov_b32 s4, 2
s_cmp_eq_u32 s24, 5
s_cbranch_scc0 fh2_251
s_lshl_b32 s24, s12, 6
s_add_u32 s24, s24, 0x1801000
v_mov_b32 v14, s9
v_mov_b32 v15, 0
s_mov_b64 exec, 1
buffer_store_dword v14, v15, s[28:31], s24 offen sc1
s_mov_b64 exec, -1
s_branch fh2_251
fh1_250:
s_getreg_b32 s24, hwreg(HW_REG_IB_STS, 0, 4)
s_cmp_eq_u32 s24, 0
s_cbranch_scc0 fh2_251
v_mov_b32 v14, 159908
v_mov_b32 v15, 1
s_mov_b64 exec, 1
ds_add_rtn_u32 v3, v14, v15
s_mov_b64 exec, -1
s_mov_b32 s4, 1
fh2_251:
s_barrier
v_mfma_f32_32x32x16_bf16 v[192:207], v[132:135], v[128:131], v[192:207]
ds_read_b128 v[64:67], v8 offset:0
ds_read_b64_tr_b16 v[68:69], v13 offset:0
ds_read_b64_tr_b16 v[70:71], v13 offset:512
v_mfma_f32_32x32x16_bf16 v[208:223], v[136:139], v[128:131], v[208:223]
ds_read_b64_tr_b16 v[72:73], v13 offset:8192
ds_read_b64_tr_b16 v[74:75], v13 offset:8704
v_mfma_f32_32x32x16_bf16 v[224:239], v[140:143], v[128:131], v[224:239]
ds_read_b64_tr_b16 v[76:77], v13 offset:16384
ds_read_b64_tr_b16 v[78:79], v13 offset:16896
v_mfma_f32_32x32x16_bf16 v[192:207], v[148:151], v[144:147], v[192:207]
ds_read_b128 v[80:83], v9 offset:0
ds_read_b64_tr_b16 v[84:85], v13 offset:2048
ds_read_b64_tr_b16 v[86:87], v13 offset:2560
v_mfma_f32_32x32x16_bf16 v[208:223], v[152:155], v[144:147], v[208:223]
ds_read_b64_tr_b16 v[88:89], v13 offset:10240
ds_read_b64_tr_b16 v[90:91], v13 offset:10752
v_mfma_f32_32x32x16_bf16 v[224:239], v[156:159], v[144:147], v[224:239]
ds_read_b64_tr_b16 v[92:93], v13 offset:18432
ds_read_b64_tr_b16 v[94:95], v13 offset:18944
v_mfma_f32_32x32x16_bf16 v[192:207], v[164:167], v[160:163], v[192:207]
ds_read_b128 v[96:99], v10 offset:0
ds_read_b64_tr_b16 v[100:101], v13 offset:4096
ds_read_b64_tr_b16 v[102:103], v13 offset:4608
v_mfma_f32_32x32x16_bf16 v[208:223], v[168:171], v[160:163], v[208:223]
ds_read_b64_tr_b16 v[104:105], v13 offset:12288
ds_read_b64_tr_b16 v[106:107], v13 offset:12800
v_mfma_f32_32x32x16_bf16 v[224:239], v[172:175], v[160:163], v[224:239]
ds_read_b64_tr_b16 v[108:109], v13 offset:20480
ds_read_b64_tr_b16 v[110:111], v13 offset:20992
v_mfma_f32_32x32x16_bf16 v[192:207], v[180:183], v[176:179], v[192:207]
ds_read_b128 v[112:115], v11 offset:0
ds_read_b64_tr_b16 v[116:117], v13 offset:6144
ds_read_b64_tr_b16 v[118:119], v13 offset:6656
v_mfma_f32_32x32x16_bf16 v[208:223], v[184:187], v[176:179], v[208:223]
ds_read_b64_tr_b16 v[120:121], v13 offset:14336
ds_read_b64_tr_b16 v[122:123], v13 offset:14848
v_mfma_f32_32x32x16_bf16 v[224:239], v[188:191], v[176:179], v[224:239]
ds_read_b64_tr_b16 v[124:125], v13 offset:22528
ds_read_b64_tr_b16 v[126:127], v13 offset:23040
s_waitcnt lgkmcnt(0)
s_cmp_eq_u32 s4, 2
s_cbranch_scc1 fh2_253
s_cmp_eq_u32 s4, 1
s_cbranch_scc0 fh1_252
v_readfirstlane_b32 s24, v3
s_mov_b32 s4, 2
s_cmp_eq_u32 s24, 5
s_cbranch_scc0 fh2_253
s_lshl_b32 s24, s12, 6
s_add_u32 s24, s24, 0x1801000
v_mov_b32 v14, s9
v_mov_b32 v15, 0
s_mov_b64 exec, 1
buffer_store_dword v14, v15, s[28:31], s24 offen sc1
s_mov_b64 exec, -1
s_branch fh2_253
fh1_252:
s_getreg_b32 s24, hwreg(HW_REG_IB_STS, 0, 4)
s_cmp_eq_u32 s24, 0
s_cbranch_scc0 fh2_253
v_mov_b32 v14, 159908
v_mov_b32 v15, 1
s_mov_b64 exec, 1
ds_add_rtn_u32 v3, v14, v15
s_mov_b64 exec, -1
s_mov_b32 s4, 1
fh2_253:
s_barrier
v_mfma_f32_32x32x16_bf16 v[192:207], v[68:71], v[64:67], v[192:207]
ds_read_b128 v[128:131], v8 offset:32768
ds_read_b64_tr_b16 v[132:133], v13 offset:32768
ds_read_b64_tr_b16 v[134:135], v13 offset:33280
v_mfma_f32_32x32x16_bf16 v[208:223], v[72:75], v[64:67], v[208:223]
ds_read_b64_tr_b16 v[136:137], v13 offset:40960
ds_read_b64_tr_b16 v[138:139], v13 offset:41472
v_mfma_f32_32x32x16_bf16 v[224:239], v[76:79], v[64:67], v[224:239]
ds_read_b64_tr_b16 v[140:141], v13 offset:49152
ds_read_b64_tr_b16 v[142:143], v13 offset:49664
v_mfma_f32_32x32x16_bf16 v[192:207], v[84:87], v[80:83], v[192:207]
ds_read_b128 v[144:147], v9 offset:32768
ds_read_b64_tr_b16 v[148:149], v13 offset:34816
ds_read_b64_tr_b16 v[150:151], v13 offset:35328
v_mfma_f32_32x32x16_bf16 v[208:223], v[88:91], v[80:83], v[208:223]
ds_read_b64_tr_b16 v[152:153], v13 offset:43008
ds_read_b64_tr_b16 v[154:155], v13 offset:43520
v_mfma_f32_32x32x16_bf16 v[224:239], v[92:95], v[80:83], v[224:239]
ds_read_b64_tr_b16 v[156:157], v13 offset:51200
ds_read_b64_tr_b16 v[158:159], v13 offset:51712
v_mfma_f32_32x32x16_bf16 v[192:207], v[100:103], v[96:99], v[192:207]
ds_read_b128 v[160:163], v10 offset:32768
ds_read_b64_tr_b16 v[164:165], v13 offset:36864
ds_read_b64_tr_b16 v[166:167], v13 offset:37376
v_mfma_f32_32x32x16_bf16 v[208:223], v[104:107], v[96:99], v[208:223]
ds_read_b64_tr_b16 v[168:169], v13 offset:45056
ds_read_b64_tr_b16 v[170:171], v13 offset:45568
v_mfma_f32_32x32x16_bf16 v[224:239], v[108:111], v[96:99], v[224:239]
ds_read_b64_tr_b16 v[172:173], v13 offset:53248
ds_read_b64_tr_b16 v[174:175], v13 offset:53760
v_mfma_f32_32x32x16_bf16 v[192:207], v[116:119], v[112:115], v[192:207]
ds_read_b128 v[176:179], v11 offset:32768
ds_read_b64_tr_b16 v[180:181], v13 offset:38912
ds_read_b64_tr_b16 v[182:183], v13 offset:39424
v_mfma_f32_32x32x16_bf16 v[208:223], v[120:123], v[112:115], v[208:223]
ds_read_b64_tr_b16 v[184:185], v13 offset:47104
ds_read_b64_tr_b16 v[186:187], v13 offset:47616
v_mfma_f32_32x32x16_bf16 v[224:239], v[124:127], v[112:115], v[224:239]
ds_read_b64_tr_b16 v[188:189], v13 offset:55296
ds_read_b64_tr_b16 v[190:191], v13 offset:55808
s_waitcnt lgkmcnt(0)
s_cmp_eq_u32 s4, 2
s_cbranch_scc1 fh2_255
s_cmp_eq_u32 s4, 1
s_cbranch_scc0 fh1_254
v_readfirstlane_b32 s24, v3
s_mov_b32 s4, 2
s_cmp_eq_u32 s24, 5
s_cbranch_scc0 fh2_255
s_lshl_b32 s24, s12, 6
s_add_u32 s24, s24, 0x1801000
v_mov_b32 v14, s9
v_mov_b32 v15, 0
s_mov_b64 exec, 1
buffer_store_dword v14, v15, s[28:31], s24 offen sc1
s_mov_b64 exec, -1
s_branch fh2_255
fh1_254:
s_getreg_b32 s24, hwreg(HW_REG_IB_STS, 0, 4)
s_cmp_eq_u32 s24, 0
s_cbranch_scc0 fh2_255
v_mov_b32 v14, 159908
v_mov_b32 v15, 1
s_mov_b64 exec, 1
ds_add_rtn_u32 v3, v14, v15
s_mov_b64 exec, -1
s_mov_b32 s4, 1
fh2_255:
s_mov_b32 s26, 0
fhfin_256:
s_waitcnt lgkmcnt(0)
s_cmp_eq_u32 s4, 2
s_cbranch_scc1 fh2_259
s_cmp_eq_u32 s4, 1
s_cbranch_scc0 fh1_258
v_readfirstlane_b32 s24, v3
s_mov_b32 s4, 2
s_cmp_eq_u32 s24, 5
s_cbranch_scc0 fh2_259
s_lshl_b32 s24, s12, 6
s_add_u32 s24, s24, 0x1801000
v_mov_b32 v14, s9
v_mov_b32 v15, 0
s_mov_b64 exec, 1
buffer_store_dword v14, v15, s[28:31], s24 offen sc1
s_mov_b64 exec, -1
s_branch fh2_259
fh1_258:
s_waitcnt vmcnt(0)
v_mov_b32 v14, 159908
v_mov_b32 v15, 1
s_mov_b64 exec, 1
ds_add_rtn_u32 v3, v14, v15
s_mov_b64 exec, -1
s_mov_b32 s4, 1
fh2_259:
s_cmp_eq_u32 s4, 2
s_cbranch_scc1 fhout_257
s_add_u32 s26, s26, 1
s_cmp_lt_u32 s26, 4000000
s_cbranch_scc1 fhfin_256
fhout_257:
s_waitcnt lgkmcnt(0)
v_mov_b32 v14, 159896
v_mov_b32 v15, 1
s_mov_b64 exec, 1
ds_add_u32 v14, v15
s_mov_b64 exec, -1
v_mfma_f32_32x32x16_bf16 v[208:223], v[136:139], v[128:131], v[208:223]
v_mfma_f32_32x32x16_bf16 v[208:223], v[152:155], v[144:147], v[208:223]
v_mfma_f32_32x32x16_bf16 v[208:223], v[168:171], v[160:163], v[208:223]
v_mfma_f32_32x32x16_bf16 v[208:223], v[184:187], v[176:179], v[208:223]
v_mfma_f32_32x32x16_bf16 v[224:239], v[140:143], v[128:131], v[224:239]
v_mfma_f32_32x32x16_bf16 v[224:239], v[156:159], v[144:147], v[224:239]
v_mfma_f32_32x32x16_bf16 v[224:239], v[172:175], v[160:163], v[224:239]
v_mfma_f32_32x32x16_bf16 v[224:239], v[188:191], v[176:179], v[224:239]
v_mfma_f32_32x32x16_bf16 v[192:207], v[132:135], v[128:131], v[192:207]
v_mfma_f32_32x32x16_bf16 v[192:207], v[148:151], v[144:147], v[192:207]
v_mfma_f32_32x32x16_bf16 v[192:207], v[164:167], v[160:163], v[192:207]
v_mfma_f32_32x32x16_bf16 v[192:207], v[180:183], v[176:179], v[192:207]
v_bfe_u32 v10, v0, 4, 1
v_lshrrev_b32 v11, 5, v0
v_bfe_u32 v12, v0, 2, 2
v_lshl_add_u32 v12, v11, 2, v12
v_lshlrev_b32 v12, 5, v12
v_and_b32 v13, 3, v0
v_lshl_add_u32 v12, v13, 3, v12
v_lshl_add_u32 v12, v10, 9, v12
s_lshl_b32 s18, s13, 10
s_add_u32 s18, s18, 131072
v_add_u32 v12, s18, v12
ds_read_b64_tr_b16 v[24:25], v12
ds_read_b64_tr_b16 v[26:27], v12 offset:256
v_subrev_u32 v13, 1, v10
v_sub_u32 v14, 0, v10
s_waitcnt lgkmcnt(0)
v_and_b32 v16, v24, v13
v_and_b32 v20, v24, v14
v_and_b32 v17, v25, v13
v_and_b32 v21, v25, v14
v_and_b32 v18, v26, v13
v_and_b32 v22, v26, v14
v_and_b32 v19, v27, v13
v_and_b32 v23, v27, v14
v_cvt_pk_bf16_f32 v28, v208, v209
v_cvt_pk_bf16_f32 v29, v210, v211
v_cvt_pk_bf16_f32 v30, v212, v213
v_cvt_pk_bf16_f32 v31, v214, v215
v_cvt_pk_bf16_f32 v32, v216, v217
v_cvt_pk_bf16_f32 v33, v218, v219
v_cvt_pk_bf16_f32 v34, v220, v221
v_cvt_pk_bf16_f32 v35, v222, v223
s_nop 1
v_mfma_f32_32x32x16_bf16 v[40:55], v[16:19], v[28:31], 0
v_mfma_f32_32x32x16_bf16 v[40:55], v[20:23], v[32:35], v[40:55]
v_cvt_pk_bf16_f32 v96, v224, v225
v_cvt_pk_bf16_f32 v97, v226, v227
v_cvt_pk_bf16_f32 v98, v228, v229
v_cvt_pk_bf16_f32 v99, v230, v231
v_cvt_pk_bf16_f32 v100, v232, v233
v_cvt_pk_bf16_f32 v101, v234, v235
v_cvt_pk_bf16_f32 v102, v236, v237
v_cvt_pk_bf16_f32 v103, v238, v239
v_and_b32 v14, 31, v0
s_lshl_b32 s18, s14, 5
v_add_u32 v14, s18, v14
v_lshrrev_b32 v15, 5, v0
v_lshlrev_b32 v3, 5, v14
v_lshl_add_u32 v3, v15, 3, v3
s_lshl_b32 s18, s13, 12
s_add_u32 s18, s18, 149504
v_add_u32 v3, s18, v3
ds_write_b64 v3, v[96:97] offset:0
ds_write_b64 v3, v[98:99] offset:16
ds_write_b64 v3, v[100:101] offset:2048
ds_write_b64 v3, v[102:103] offset:2064
v_max3_f32 v56, v40, v41, v42
v_min3_f32 v57, v40, v41, v42
v_max3_f32 v56, v56, v43, v44
v_min3_f32 v57, v57, v43, v44
v_max3_f32 v56, v56, v45, v46
v_min3_f32 v57, v57, v45, v46
v_max_f32 v56, v56, v47
v_min_f32 v57, v57, v47
v_mov_b32 v58, v56
v_mov_b32 v59, v57
s_nop 1
v_permlane32_swap_b32 v56, v58
v_permlane32_swap_b32 v57, v59
s_nop 1
v_max_f32 v56, v56, v58
v_min_f32 v57, v57, v59
v_mul_f32 v56, s20, v56
v_mul_f32 v57, s20, v57
v_fma_f32 v60, v40, s20, -v56
v_fma_f32 v61, v41, s20, -v56
v_fma_f32 v62, v42, s20, -v56
v_fma_f32 v63, v43, s20, -v56
v_fma_f32 v64, v44, s20, -v56
v_fma_f32 v65, v45, s20, -v56
v_fma_f32 v66, v46, s20, -v56
v_fma_f32 v67, v47, s20, -v56
v_fma_f32 v40, -v40, s20, v57
v_fma_f32 v41, -v41, s20, v57
v_fma_f32 v42, -v42, s20, v57
v_fma_f32 v43, -v43, s20, v57
v_fma_f32 v44, -v44, s20, v57
v_fma_f32 v45, -v45, s20, v57
v_fma_f32 v46, -v46, s20, v57
v_fma_f32 v47, -v47, s20, v57
v_exp_f32 v60, v60
v_exp_f32 v61, v61
v_exp_f32 v62, v62
v_exp_f32 v63, v63
v_exp_f32 v64, v64
v_exp_f32 v65, v65
v_exp_f32 v66, v66
v_exp_f32 v67, v67
v_exp_f32 v40, v40
v_exp_f32 v41, v41
v_exp_f32 v42, v42
v_exp_f32 v43, v43
v_exp_f32 v44, v44
v_exp_f32 v45, v45
v_exp_f32 v46, v46
v_exp_f32 v47, v47
v_add_f32 v56, v60, v61
v_add_f32 v58, v62, v63
v_add_f32 v57, v40, v41
v_add_f32 v59, v42, v43
v_add_f32 v56, v56, v64
v_add_f32 v58, v58, v65
v_add_f32 v57, v57, v44
v_add_f32 v59, v59, v45
v_add_f32 v56, v56, v66
v_add_f32 v58, v58, v67
v_add_f32 v57, v57, v46
v_add_f32 v59, v59, v47
v_add_f32 v56, v56, v58
v_add_f32 v57, v57, v59
v_mov_b32 v58, v56
v_mov_b32 v59, v57
s_nop 1
v_permlane32_swap_b32 v56, v58
v_permlane32_swap_b32 v57, v59
s_nop 1
v_add_f32 v56, v56, v58
v_add_f32 v57, v57, v59
v_rcp_f32 v56, v56
v_rcp_f32 v57, v57
s_nop 0
v_mul_f32 v60, v60, v56
v_mul_f32 v61, v61, v56
v_mul_f32 v62, v62, v56
v_mul_f32 v63, v63, v56
v_mul_f32 v64, v64, v56
v_mul_f32 v65, v65, v56
v_mul_f32 v66, v66, v56
v_mul_f32 v67, v67, v56
v_mul_f32 v40, v40, v57
v_mul_f32 v41, v41, v57
v_mul_f32 v42, v42, v57
v_mul_f32 v43, v43, v57
v_mul_f32 v44, v44, v57
v_mul_f32 v45, v45, v57
v_mul_f32 v46, v46, v57
v_mul_f32 v47, v47, v57
v_cvt_pk_bf16_f32 v72, v60, v61
v_cvt_pk_bf16_f32 v73, v62, v63
v_cvt_pk_bf16_f32 v74, v64, v65
v_cvt_pk_bf16_f32 v75, v66, v67
v_cvt_pk_bf16_f32 v76, v40, v41
v_cvt_pk_bf16_f32 v77, v42, v43
v_cvt_pk_bf16_f32 v78, v44, v45
v_cvt_pk_bf16_f32 v79, v46, v47
v_max3_f32 v56, v48, v49, v50
v_min3_f32 v57, v48, v49, v50
v_max3_f32 v56, v56, v51, v52
v_min3_f32 v57, v57, v51, v52
v_max3_f32 v56, v56, v53, v54
v_min3_f32 v57, v57, v53, v54
v_max_f32 v56, v56, v55
v_min_f32 v57, v57, v55
v_mov_b32 v58, v56
v_mov_b32 v59, v57
s_nop 1
v_permlane32_swap_b32 v56, v58
v_permlane32_swap_b32 v57, v59
s_nop 1
v_max_f32 v56, v56, v58
v_min_f32 v57, v57, v59
v_mul_f32 v56, s20, v56
v_mul_f32 v57, s20, v57
v_fma_f32 v60, v48, s20, -v56
v_fma_f32 v61, v49, s20, -v56
v_fma_f32 v62, v50, s20, -v56
v_fma_f32 v63, v51, s20, -v56
v_fma_f32 v64, v52, s20, -v56
v_fma_f32 v65, v53, s20, -v56
v_fma_f32 v66, v54, s20, -v56
v_fma_f32 v67, v55, s20, -v56
v_fma_f32 v48, -v48, s20, v57
v_fma_f32 v49, -v49, s20, v57
v_fma_f32 v50, -v50, s20, v57
v_fma_f32 v51, -v51, s20, v57
v_fma_f32 v52, -v52, s20, v57
v_fma_f32 v53, -v53, s20, v57
v_fma_f32 v54, -v54, s20, v57
v_fma_f32 v55, -v55, s20, v57
v_exp_f32 v60, v60
v_exp_f32 v61, v61
v_exp_f32 v62, v62
v_exp_f32 v63, v63
v_exp_f32 v64, v64
v_exp_f32 v65, v65
v_exp_f32 v66, v66
v_exp_f32 v67, v67
v_exp_f32 v48, v48
v_exp_f32 v49, v49
v_exp_f32 v50, v50
v_exp_f32 v51, v51
v_exp_f32 v52, v52
v_exp_f32 v53, v53
v_exp_f32 v54, v54
v_exp_f32 v55, v55
v_add_f32 v56, v60, v61
v_add_f32 v58, v62, v63
v_add_f32 v57, v48, v49
v_add_f32 v59, v50, v51
v_add_f32 v56, v56, v64
v_add_f32 v58, v58, v65
v_add_f32 v57, v57, v52
v_add_f32 v59, v59, v53
v_add_f32 v56, v56, v66
v_add_f32 v58, v58, v67
v_add_f32 v57, v57, v54
v_add_f32 v59, v59, v55
v_add_f32 v56, v56, v58
v_add_f32 v57, v57, v59
v_mov_b32 v58, v56
v_mov_b32 v59, v57
s_nop 1
v_permlane32_swap_b32 v56, v58
v_permlane32_swap_b32 v57, v59
s_nop 1
v_add_f32 v56, v56, v58
v_add_f32 v57, v57, v59
v_rcp_f32 v56, v56
v_rcp_f32 v57, v57
s_nop 0
v_mul_f32 v60, v60, v56
v_mul_f32 v61, v61, v56
v_mul_f32 v62, v62, v56
v_mul_f32 v63, v63, v56
v_mul_f32 v64, v64, v56
v_mul_f32 v65, v65, v56
v_mul_f32 v66, v66, v56
v_mul_f32 v67, v67, v56
v_mul_f32 v48, v48, v57
v_mul_f32 v49, v49, v57
v_mul_f32 v50, v50, v57
v_mul_f32 v51, v51, v57
v_mul_f32 v52, v52, v57
v_mul_f32 v53, v53, v57
v_mul_f32 v54, v54, v57
v_mul_f32 v55, v55, v57
v_cvt_pk_bf16_f32 v80, v60, v61
v_cvt_pk_bf16_f32 v81, v62, v63
v_cvt_pk_bf16_f32 v82, v64, v65
v_cvt_pk_bf16_f32 v83, v66, v67
v_cvt_pk_bf16_f32 v84, v48, v49
v_cvt_pk_bf16_f32 v85, v50, v51
v_cvt_pk_bf16_f32 v86, v52, v53
v_cvt_pk_bf16_f32 v87, v54, v55
v_lshlrev_b32 v3, 6, v14
v_lshl_add_u32 v3, v15, 3, v3
s_lshl_b32 s18, s13, 13
s_add_u32 s18, s18, 133120
v_add_u32 v3, s18, v3
ds_write_b64 v3, v[72:73] offset:0
ds_write_b64 v3, v[74:75] offset:16
ds_write_b64 v3, v[76:77] offset:32
ds_write_b64 v3, v[78:79] offset:48
ds_write_b64 v3, v[80:81] offset:4096
ds_write_b64 v3, v[82:83] offset:4112
ds_write_b64 v3, v[84:85] offset:4128
ds_write_b64 v3, v[86:87] offset:4144
v_cvt_pk_bf16_f32 v28, v192, v193
v_cvt_pk_bf16_f32 v29, v194, v195
v_cvt_pk_bf16_f32 v30, v196, v197
v_cvt_pk_bf16_f32 v31, v198, v199
v_cvt_pk_bf16_f32 v32, v200, v201
v_cvt_pk_bf16_f32 v33, v202, v203
v_cvt_pk_bf16_f32 v34, v204, v205
v_cvt_pk_bf16_f32 v35, v206, v207
s_nop 1
v_mfma_f32_32x32x16_bf16 v[40:55], v[16:19], v[28:31], 0
v_mfma_f32_32x32x16_bf16 v[40:55], v[20:23], v[32:35], v[40:55]
s_waitcnt lgkmcnt(0)
v_mov_b32 v14, 159884
v_mov_b32 v15, 1
s_mov_b64 exec, 1
ds_add_u32 v14, v15
s_mov_b64 exec, -1
v_mov_b32 v14, 159884
s_mov_b32 s25, 0
sw_260:
ds_read_b32 v15, v14
s_add_u32 s25, s25, 1
s_waitcnt lgkmcnt(0)
v_readfirstlane_b32 s24, v15
s_cmp_ge_u32 s24, 4
s_cbranch_scc1 swd_261
s_cmp_lt_u32 s25, 4000000
s_cbranch_scc1 sw_260
swd_261:
v_lshrrev_b32 v15, 5, v0
v_bfe_u32 v14, v0, 2, 2
v_lshl_add_u32 v14, v15, 3, v14
v_and_b32 v13, 3, v0
v_lshlrev_b32 v13, 3, v13
v_bfe_u32 v12, v0, 4, 1
v_lshl_add_u32 v3, v14, 6, v13
v_lshl_add_u32 v3, v12, 5, v3
s_lshl_b32 s18, s15, 12
s_add_u32 s18, s18, 133120
v_add_u32 v3, s18, v3
v_lshl_add_u32 v4, v14, 5, v13
s_lshl_b32 s18, s15, 11
s_add_u32 s18, s18, 149504
s_sub_u32 s16, 157824, s18
v_mul_lo_u32 v12, v12, s16
v_add3_u32 v4, v4, v12, s18
ds_read_b64_tr_b16 v[100:101], v3 offset:0
ds_read_b64_tr_b16 v[102:103], v3 offset:256
ds_read_b64_tr_b16 v[116:117], v4 offset:0
ds_read_b64_tr_b16 v[118:119], v4 offset:128
ds_read_b64_tr_b16 v[104:105], v3 offset:1024
ds_read_b64_tr_b16 v[106:107], v3 offset:1280
ds_read_b64_tr_b16 v[120:121], v4 offset:512
ds_read_b64_tr_b16 v[122:123], v4 offset:640
ds_read_b64_tr_b16 v[108:109], v3 offset:2048
ds_read_b64_tr_b16 v[110:111], v3 offset:2304
ds_read_b64_tr_b16 v[124:125], v4 offset:1024
ds_read_b64_tr_b16 v[126:127], v4 offset:1152
ds_read_b64_tr_b16 v[112:113], v3 offset:3072
ds_read_b64_tr_b16 v[114:115], v3 offset:3328
ds_read_b64_tr_b16 v[128:129], v4 offset:1536
ds_read_b64_tr_b16 v[130:131], v4 offset:1664
s_waitcnt lgkmcnt(12)
v_mfma_f32_32x32x16_bf16 v[132:147], v[100:103], v[116:119], 0
s_waitcnt lgkmcnt(8)
v_mfma_f32_32x32x16_bf16 v[132:147], v[104:107], v[120:123], v[132:147]
s_waitcnt lgkmcnt(4)
v_mfma_f32_32x32x16_bf16 v[132:147], v[108:111], v[124:127], v[132:147]
s_waitcnt lgkmcnt(0)
v_mfma_f32_32x32x16_bf16 v[132:147], v[112:115], v[128:131], v[132:147]
v_and_b32 v14, 31, v0
v_lshrrev_b32 v15, 5, v0
v_mul_u32_u24 v15, 17, v15
v_add_u32 v15, v15, v14
v_lshlrev_b32 v15, 4, v15
s_lshl_b32 s16, s3, 5
s_lshl_b32 s18, s11, 2
s_add_u32 s16, s16, s18
s_add_u32 s16, s16, s15
s_mul_i32 s16, s16, 2176
s_add_u32 s16, s16, 0xc00000
v_cmp_ge_u32 vcc, 16, v14
s_nop 4
s_and_saveexec_b64 s[4:5], vcc
buffer_store_dwordx4 v[132:135], v15, s[28:31], s16 offen offset:0 sc1
buffer_store_dwordx4 v[136:139], v15, s[28:31], s16 offen offset:544 sc1
buffer_store_dwordx4 v[140:143], v15, s[28:31], s16 offen offset:1088 sc1
buffer_store_dwordx4 v[144:147], v15, s[28:31], s16 offen offset:1632 sc1
s_mov_b64 exec, s[4:5]
s_waitcnt vmcnt(0)
v_mov_b32 v14, 159888
v_mov_b32 v15, 1
s_mov_b64 exec, 1
ds_add_u32 v14, v15
s_mov_b64 exec, -1
v_mov_b32 v14, 159888
s_mov_b32 s25, 0
sw_262:
ds_read_b32 v15, v14
s_add_u32 s25, s25, 1
s_waitcnt lgkmcnt(0)
v_readfirstlane_b32 s24, v15
s_cmp_ge_u32 s24, 4
s_cbranch_scc1 swd_263
s_cmp_lt_u32 s25, 4000000
s_cbranch_scc1 sw_262
swd_263:
s_cmp_eq_u32 s15, 0
s_cbranch_scc0 nof1_264
s_lshl_b32 s24, s11, 5
s_add_u32 s24, s24, s3
s_lshl_b32 s24, s24, 6
s_add_u32 s24, s24, 0x1808000
v_mov_b32 v14, s9
v_mov_b32 v15, 0
s_mov_b64 exec, 1
buffer_store_dword v14, v15, s[28:31], s24 offen sc1
s_mov_b64 exec, -1
nof1_264:
v_max3_f32 v56, v40, v41, v42
v_min3_f32 v57, v40, v41, v42
v_max3_f32 v56, v56, v43, v44
v_min3_f32 v57, v57, v43, v44
v_max3_f32 v56, v56, v45, v46
v_min3_f32 v57, v57, v45, v46
v_max_f32 v56, v56, v47
v_min_f32 v57, v57, v47
v_mov_b32 v58, v56
v_mov_b32 v59, v57
s_nop 1
v_permlane32_swap_b32 v56, v58
v_permlane32_swap_b32 v57, v59
s_nop 1
v_max_f32 v56, v56, v58
v_min_f32 v57, v57, v59
v_mul_f32 v56, s20, v56
v_mul_f32 v57, s20, v57
v_fma_f32 v60, v40, s20, -v56
v_fma_f32 v61, v41, s20, -v56
v_fma_f32 v62, v42, s20, -v56
v_fma_f32 v63, v43, s20, -v56
v_fma_f32 v64, v44, s20, -v56
v_fma_f32 v65, v45, s20, -v56
v_fma_f32 v66, v46, s20, -v56
v_fma_f32 v67, v47, s20, -v56
v_fma_f32 v40, -v40, s20, v57
v_fma_f32 v41, -v41, s20, v57
v_fma_f32 v42, -v42, s20, v57
v_fma_f32 v43, -v43, s20, v57
v_fma_f32 v44, -v44, s20, v57
v_fma_f32 v45, -v45, s20, v57
v_fma_f32 v46, -v46, s20, v57
v_fma_f32 v47, -v47, s20, v57
v_exp_f32 v60, v60
v_exp_f32 v61, v61
v_exp_f32 v62, v62
v_exp_f32 v63, v63
v_exp_f32 v64, v64
v_exp_f32 v65, v65
v_exp_f32 v66, v66
v_exp_f32 v67, v67
v_exp_f32 v40, v40
v_exp_f32 v41, v41
v_exp_f32 v42, v42
v_exp_f32 v43, v43
v_exp_f32 v44, v44
v_exp_f32 v45, v45
v_exp_f32 v46, v46
v_exp_f32 v47, v47
v_add_f32 v56, v60, v61
v_add_f32 v58, v62, v63
v_add_f32 v57, v40, v41
v_add_f32 v59, v42, v43
v_add_f32 v56, v56, v64
v_add_f32 v58, v58, v65
v_add_f32 v57, v57, v44
v_add_f32 v59, v59, v45
v_add_f32 v56, v56, v66
v_add_f32 v58, v58, v67
v_add_f32 v57, v57, v46
v_add_f32 v59, v59, v47
v_add_f32 v56, v56, v58
v_add_f32 v57, v57, v59
v_mov_b32 v58, v56
v_mov_b32 v59, v57
s_nop 1
v_permlane32_swap_b32 v56, v58
v_permlane32_swap_b32 v57, v59
s_nop 1
v_add_f32 v56, v56, v58
v_add_f32 v57, v57, v59
v_rcp_f32 v56, v56
v_rcp_f32 v57, v57
s_nop 0
v_mul_f32 v60, v60, v56
v_mul_f32 v61, v61, v56
v_mul_f32 v62, v62, v56
v_mul_f32 v63, v63, v56
v_mul_f32 v64, v64, v56
v_mul_f32 v65, v65, v56
v_mul_f32 v66, v66, v56
v_mul_f32 v67, v67, v56
v_mul_f32 v40, v40, v57
v_mul_f32 v41, v41, v57
v_mul_f32 v42, v42, v57
v_mul_f32 v43, v43, v57
v_mul_f32 v44, v44, v57
v_mul_f32 v45, v45, v57
v_mul_f32 v46, v46, v57
v_mul_f32 v47, v47, v57
v_cvt_pk_bf16_f32 v72, v60, v61
v_cvt_pk_bf16_f32 v73, v62, v63
v_cvt_pk_bf16_f32 v74, v64, v65
v_cvt_pk_bf16_f32 v75, v66, v67
v_cvt_pk_bf16_f32 v76, v40, v41
v_cvt_pk_bf16_f32 v77, v42, v43
v_cvt_pk_bf16_f32 v78, v44, v45
v_cvt_pk_bf16_f32 v79, v46, v47
v_max3_f32 v56, v48, v49, v50
v_min3_f32 v57, v48, v49, v50
v_max3_f32 v56, v56, v51, v52
v_min3_f32 v57, v57, v51, v52
v_max3_f32 v56, v56, v53, v54
v_min3_f32 v57, v57, v53, v54
v_max_f32 v56, v56, v55
v_min_f32 v57, v57, v55
v_mov_b32 v58, v56
v_mov_b32 v59, v57
s_nop 1
v_permlane32_swap_b32 v56, v58
v_permlane32_swap_b32 v57, v59
s_nop 1
v_max_f32 v56, v56, v58
v_min_f32 v57, v57, v59
v_mul_f32 v56, s20, v56
v_mul_f32 v57, s20, v57
v_fma_f32 v60, v48, s20, -v56
v_fma_f32 v61, v49, s20, -v56
v_fma_f32 v62, v50, s20, -v56
v_fma_f32 v63, v51, s20, -v56
v_fma_f32 v64, v52, s20, -v56
v_fma_f32 v65, v53, s20, -v56
v_fma_f32 v66, v54, s20, -v56
v_fma_f32 v67, v55, s20, -v56
v_fma_f32 v48, -v48, s20, v57
v_fma_f32 v49, -v49, s20, v57
v_fma_f32 v50, -v50, s20, v57
v_fma_f32 v51, -v51, s20, v57
v_fma_f32 v52, -v52, s20, v57
v_fma_f32 v53, -v53, s20, v57
v_fma_f32 v54, -v54, s20, v57
v_fma_f32 v55, -v55, s20, v57
v_exp_f32 v60, v60
v_exp_f32 v61, v61
v_exp_f32 v62, v62
v_exp_f32 v63, v63
v_exp_f32 v64, v64
v_exp_f32 v65, v65
v_exp_f32 v66, v66
v_exp_f32 v67, v67
v_exp_f32 v48, v48
v_exp_f32 v49, v49
v_exp_f32 v50, v50
v_exp_f32 v51, v51
v_exp_f32 v52, v52
v_exp_f32 v53, v53
v_exp_f32 v54, v54
v_exp_f32 v55, v55
v_add_f32 v56, v60, v61
v_add_f32 v58, v62, v63
v_add_f32 v57, v48, v49
v_add_f32 v59, v50, v51
v_add_f32 v56, v56, v64
v_add_f32 v58, v58, v65
v_add_f32 v57, v57, v52
v_add_f32 v59, v59, v53
v_add_f32 v56, v56, v66
v_add_f32 v58, v58, v67
v_add_f32 v57, v57, v54
v_add_f32 v59, v59, v55
v_add_f32 v56, v56, v58
v_add_f32 v57, v57, v59
v_mov_b32 v58, v56
v_mov_b32 v59, v57
s_nop 1
v_permlane32_swap_b32 v56, v58
v_permlane32_swap_b32 v57, v59
s_nop 1
v_add_f32 v56, v56, v58
v_add_f32 v57, v57, v59
v_rcp_f32 v56, v56
v_rcp_f32 v57, v57
s_nop 0
v_mul_f32 v60, v60, v56
v_mul_f32 v61, v61, v56
v_mul_f32 v62, v62, v56
v_mul_f32 v63, v63, v56
v_mul_f32 v64, v64, v56
v_mul_f32 v65, v65, v56
v_mul_f32 v66, v66, v56
v_mul_f32 v67, v67, v56
v_mul_f32 v48, v48, v57
v_mul_f32 v49, v49, v57
v_mul_f32 v50, v50, v57
v_mul_f32 v51, v51, v57
v_mul_f32 v52, v52, v57
v_mul_f32 v53, v53, v57
v_mul_f32 v54, v54, v57
v_mul_f32 v55, v55, v57
v_cvt_pk_bf16_f32 v80, v60, v61
v_cvt_pk_bf16_f32 v81, v62, v63
v_cvt_pk_bf16_f32 v82, v64, v65
v_cvt_pk_bf16_f32 v83, v66, v67
v_cvt_pk_bf16_f32 v84, v48, v49
v_cvt_pk_bf16_f32 v85, v50, v51
v_cvt_pk_bf16_f32 v86, v52, v53
v_cvt_pk_bf16_f32 v87, v54, v55
s_lshl_b32 s18, s15, 12
s_add_u32 s18, s18, 133120
v_add_u32 v3, s18, v2
ds_write_b128 v3, v[72:75] offset:0
ds_write_b128 v3, v[76:79] offset:1024
ds_write_b128 v3, v[80:83] offset:2048
ds_write_b128 v3, v[84:87] offset:3072
s_waitcnt lgkmcnt(0)
s_barrier
v_and_b32 v11, 31, v0
v_lshrrev_b32 v12, 5, v0
s_lshl_b32 s18, s14, 5
s_add_u32 s18, s18, s80
v_add_u32 v13, s18, v11
v_lshlrev_b32 v14, 1, v13
buffer_load_ushort v9, v14, s[44:47], 0 offen
v_lshlrev_b32 v8, 2, v13
s_mov_b32 s18, 0x780000
buffer_load_dword v8, v8, s[28:31], s18 offen sc1
v_lshlrev_b32 v10, 10, v13
s_lshl_b32 s18, s13, 5
s_lshl_b32 s16, s81, 6
s_add_u32 s18, s18, s16
s_lshl_b32 s18, s18, 1
v_lshlrev_b32 v14, 4, v12
v_add3_u32 v10, v10, v14, s18
v_lshlrev_b32 v14, 10, v12
v_lshlrev_b32 v15, 4, v11
v_add_u32 v14, v14, v15
s_lshl_b32 s18, s13, 9
v_add_u32 v2, s18, v14
s_lshl_b32 s18, s14, 9
s_add_u32 s18, s18, 8192
v_add_u32 v5, s18, v14
v_bfe_u32 v14, v0, 2, 2
v_lshl_add_u32 v15, v12, 3, v14
v_lshlrev_b32 v15, 7, v15
v_bfe_u32 v13, v0, 4, 1
v_lshl_add_u32 v15, v13, 5, v15
v_and_b32 v13, 3, v0
v_lshl_add_u32 v15, v13, 3, v15
v_lshrrev_b32 v14, 1, v14
v_xor_b32 v13, s13, v14
v_lshl_add_u32 v4, v13, 6, v15
v_xor_b32 v13, s14, v14
v_lshl_add_u32 v3, v13, 6, v15
v_add_u32 v3, 8192, v3
s_mov_b32 s23, 0
v_mov_b32 v80, 0
v_mov_b32 v96, 0
v_mov_b32 v81, 0
v_mov_b32 v97, 0
v_mov_b32 v82, 0
v_mov_b32 v98, 0
v_mov_b32 v83, 0
v_mov_b32 v99, 0
v_mov_b32 v84, 0
v_mov_b32 v100, 0
v_mov_b32 v85, 0
v_mov_b32 v101, 0
v_mov_b32 v86, 0
v_mov_b32 v102, 0
v_mov_b32 v87, 0
v_mov_b32 v103, 0
v_mov_b32 v88, 0
v_mov_b32 v104, 0
v_mov_b32 v89, 0
v_mov_b32 v105, 0
v_mov_b32 v90, 0
v_mov_b32 v106, 0
v_mov_b32 v91, 0
v_mov_b32 v107, 0
v_mov_b32 v92, 0
v_mov_b32 v108, 0
v_mov_b32 v93, 0
v_mov_b32 v109, 0
v_mov_b32 v94, 0
v_mov_b32 v110, 0
v_mov_b32 v95, 0
v_mov_b32 v111, 0
v_mov_b32 v48, 0
v_mov_b32 v49, 0
v_mov_b32 v50, 0
v_mov_b32 v51, 0
v_mov_b32 v52, 0
v_mov_b32 v53, 0
v_mov_b32 v54, 0
v_mov_b32 v55, 0
v_mov_b32 v56, 0
v_mov_b32 v57, 0
v_mov_b32 v58, 0
v_mov_b32 v59, 0
v_mov_b32 v60, 0
v_mov_b32 v61, 0
v_mov_b32 v62, 0
v_mov_b32 v63, 0
v_mov_b32 v64, 0
v_mov_b32 v65, 0
v_mov_b32 v66, 0
v_mov_b32 v67, 0
v_mov_b32 v68, 0
v_mov_b32 v69, 0
v_mov_b32 v70, 0
v_mov_b32 v71, 0
v_mov_b32 v72, 0
v_mov_b32 v73, 0
v_mov_b32 v74, 0
v_mov_b32 v75, 0
v_mov_b32 v76, 0
v_mov_b32 v77, 0
v_mov_b32 v78, 0
v_mov_b32 v79, 0
s_barrier
v_add_u32 v6, s23, v2
v_add_u32 v7, s23, v3
s_add_u32 s23, s23, 16384
s_and_b32 s23, s23, 131071
s_barrier
v_mfma_f32_32x32x16_bf16 v[80:95], v[48:51], v[64:67], v[80:95]
ds_read_b128 v[16:19], v6 offset:0
ds_read_b64_tr_b16 v[32:33], v7 offset:0
ds_read_b64_tr_b16 v[34:35], v7 offset:512
v_mfma_f32_32x32x16_bf16 v[80:95], v[52:55], v[68:71], v[80:95]
ds_read_b128 v[20:23], v6 offset:2048
ds_read_b64_tr_b16 v[36:37], v7 offset:2048
ds_read_b64_tr_b16 v[38:39], v7 offset:2560
v_mfma_f32_32x32x16_bf16 v[80:95], v[56:59], v[72:75], v[80:95]
ds_read_b128 v[24:27], v6 offset:4096
ds_read_b64_tr_b16 v[40:41], v7 offset:4096
ds_read_b64_tr_b16 v[42:43], v7 offset:4608
v_mfma_f32_32x32x16_bf16 v[80:95], v[60:63], v[76:79], v[80:95]
ds_read_b128 v[28:31], v6 offset:6144
ds_read_b64_tr_b16 v[44:45], v7 offset:6144
ds_read_b64_tr_b16 v[46:47], v7 offset:6656
s_waitcnt lgkmcnt(0)
v_add_u32 v6, s23, v2
v_add_u32 v7, s23, v3
s_add_u32 s23, s23, 16384
s_and_b32 s23, s23, 131071
s_barrier
v_mfma_f32_32x32x16_bf16 v[80:95], v[16:19], v[32:35], v[80:95]
ds_read_b128 v[48:51], v6 offset:0
ds_read_b64_tr_b16 v[64:65], v7 offset:0
ds_read_b64_tr_b16 v[66:67], v7 offset:512
v_mfma_f32_32x32x16_bf16 v[80:95], v[20:23], v[36:39], v[80:95]
ds_read_b128 v[52:55], v6 offset:2048
ds_read_b64_tr_b16 v[68:69], v7 offset:2048
ds_read_b64_tr_b16 v[70:71], v7 offset:2560
v_mfma_f32_32x32x16_bf16 v[80:95], v[24:27], v[40:43], v[80:95]
ds_read_b128 v[56:59], v6 offset:4096
ds_read_b64_tr_b16 v[72:73], v7 offset:4096
ds_read_b64_tr_b16 v[74:75], v7 offset:4608
v_mfma_f32_32x32x16_bf16 v[80:95], v[28:31], v[44:47], v[80:95]
ds_read_b128 v[60:63], v6 offset:6144
ds_read_b64_tr_b16 v[76:77], v7 offset:6144
ds_read_b64_tr_b16 v[78:79], v7 offset:6656
s_waitcnt lgkmcnt(0)
s_mov_b32 s16, 1
cy_265:
v_add_u32 v6, s23, v2
v_add_u32 v7, s23, v3
s_add_u32 s23, s23, 16384
s_and_b32 s23, s23, 131071
s_barrier
s_cmp_eq_u32 s16, 5
s_cbranch_scc0 nofo_266
s_cmp_eq_u32 s15, 0
s_cbranch_scc0 nofo_266
s_lshl_b32 s24, s3, 3
s_add_u32 s24, s24, s11
s_lshl_b32 s24, s24, 6
s_add_u32 s24, s24, 0x1814000
v_mov_b32 v14, s9
v_mov_b32 v15, 0
s_mov_b64 exec, 1
buffer_store_dword v14, v15, s[28:31], s24 offen sc1
s_mov_b64 exec, -1
nofo_266:
v_mfma_f32_32x32x16_bf16 v[80:95], v[48:51], v[64:67], v[80:95]
ds_read_b128 v[16:19], v6 offset:0
ds_read_b64_tr_b16 v[32:33], v7 offset:0
ds_read_b64_tr_b16 v[34:35], v7 offset:512
v_mfma_f32_32x32x16_bf16 v[80:95], v[52:55], v[68:71], v[80:95]
ds_read_b128 v[20:23], v6 offset:2048
ds_read_b64_tr_b16 v[36:37], v7 offset:2048
ds_read_b64_tr_b16 v[38:39], v7 offset:2560
v_mfma_f32_32x32x16_bf16 v[80:95], v[56:59], v[72:75], v[80:95]
ds_read_b128 v[24:27], v6 offset:4096
ds_read_b64_tr_b16 v[40:41], v7 offset:4096
ds_read_b64_tr_b16 v[42:43], v7 offset:4608
v_mfma_f32_32x32x16_bf16 v[80:95], v[60:63], v[76:79], v[80:95]
ds_read_b128 v[28:31], v6 offset:6144
ds_read_b64_tr_b16 v[44:45], v7 offset:6144
ds_read_b64_tr_b16 v[46:47], v7 offset:6656
s_waitcnt lgkmcnt(0)
v_add_u32 v6, s23, v2
v_add_u32 v7, s23, v3
s_add_u32 s23, s23, 16384
s_and_b32 s23, s23, 131071
s_barrier
v_mfma_f32_32x32x16_bf16 v[80:95], v[16:19], v[32:35], v[80:95]
ds_read_b128 v[48:51], v6 offset:0
ds_read_b64_tr_b16 v[64:65], v7 offset:0
ds_read_b64_tr_b16 v[66:67], v7 offset:512
v_mfma_f32_32x32x16_bf16 v[80:95], v[20:23], v[36:39], v[80:95]
ds_read_b128 v[52:55], v6 offset:2048
ds_read_b64_tr_b16 v[68:69], v7 offset:2048
ds_read_b64_tr_b16 v[70:71], v7 offset:2560
v_mfma_f32_32x32x16_bf16 v[80:95], v[24:27], v[40:43], v[80:95]
ds_read_b128 v[56:59], v6 offset:4096
ds_read_b64_tr_b16 v[72:73], v7 offset:4096
ds_read_b64_tr_b16 v[74:75], v7 offset:4608
v_mfma_f32_32x32x16_bf16 v[80:95], v[28:31], v[44:47], v[80:95]
ds_read_b128 v[60:63], v6 offset:6144
ds_read_b64_tr_b16 v[76:77], v7 offset:6144
ds_read_b64_tr_b16 v[78:79], v7 offset:6656
s_waitcnt lgkmcnt(0)
s_add_u32 s16, s16, 1
s_cmp_lt_u32 s16, 11
s_cbranch_scc1 cy_265
v_add_u32 v6, s23, v4
v_add_u32 v7, s23, v5
s_add_u32 s23, s23, 16384
s_and_b32 s23, s23, 131071
s_barrier
v_mfma_f32_32x32x16_bf16 v[80:95], v[48:51], v[64:67], v[80:95]
ds_read_b64_tr_b16 v[16:17], v6 offset:0
ds_read_b64_tr_b16 v[18:19], v6 offset:512
ds_read_b128 v[32:35], v7 offset:0
v_mfma_f32_32x32x16_bf16 v[80:95], v[52:55], v[68:71], v[80:95]
ds_read_b64_tr_b16 v[20:21], v6 offset:2048
ds_read_b64_tr_b16 v[22:23], v6 offset:2560
ds_read_b128 v[36:39], v7 offset:2048
v_mfma_f32_32x32x16_bf16 v[80:95], v[56:59], v[72:75], v[80:95]
ds_read_b64_tr_b16 v[24:25], v6 offset:4096
ds_read_b64_tr_b16 v[26:27], v6 offset:4608
ds_read_b128 v[40:43], v7 offset:4096
v_mfma_f32_32x32x16_bf16 v[80:95], v[60:63], v[76:79], v[80:95]
ds_read_b64_tr_b16 v[28:29], v6 offset:6144
ds_read_b64_tr_b16 v[30:31], v6 offset:6656
ds_read_b128 v[44:47], v7 offset:6144
s_waitcnt lgkmcnt(0)
v_add_u32 v6, s23, v4
v_add_u32 v7, s23, v5
s_add_u32 s23, s23, 16384
s_and_b32 s23, s23, 131071
s_barrier
v_mfma_f32_32x32x16_bf16 v[96:111], v[16:19], v[32:35], v[96:111]
ds_read_b64_tr_b16 v[48:49], v6 offset:0
ds_read_b64_tr_b16 v[50:51], v6 offset:512
ds_read_b128 v[64:67], v7 offset:0
v_mfma_f32_32x32x16_bf16 v[96:111], v[20:23], v[36:39], v[96:111]
ds_read_b64_tr_b16 v[52:53], v6 offset:2048
ds_read_b64_tr_b16 v[54:55], v6 offset:2560
ds_read_b128 v[68:71], v7 offset:2048
v_mfma_f32_32x32x16_bf16 v[96:111], v[24:27], v[40:43], v[96:111]
ds_read_b64_tr_b16 v[56:57], v6 offset:4096
ds_read_b64_tr_b16 v[58:59], v6 offset:4608
ds_read_b128 v[72:75], v7 offset:4096
v_mfma_f32_32x32x16_bf16 v[96:111], v[28:31], v[44:47], v[96:111]
ds_read_b64_tr_b16 v[60:61], v6 offset:6144
ds_read_b64_tr_b16 v[62:63], v6 offset:6656
ds_read_b128 v[76:79], v7 offset:6144
s_waitcnt lgkmcnt(0)
s_mov_b32 s16, 0
ca_267:
v_add_u32 v6, s23, v4
v_add_u32 v7, s23, v5
s_add_u32 s23, s23, 16384
s_and_b32 s23, s23, 131071
s_barrier
v_mfma_f32_32x32x16_bf16 v[96:111], v[48:51], v[64:67], v[96:111]
ds_read_b64_tr_b16 v[16:17], v6 offset:0
ds_read_b64_tr_b16 v[18:19], v6 offset:512
ds_read_b128 v[32:35], v7 offset:0
v_mfma_f32_32x32x16_bf16 v[96:111], v[52:55], v[68:71], v[96:111]
ds_read_b64_tr_b16 v[20:21], v6 offset:2048
ds_read_b64_tr_b16 v[22:23], v6 offset:2560
ds_read_b128 v[36:39], v7 offset:2048
v_mfma_f32_32x32x16_bf16 v[96:111], v[56:59], v[72:75], v[96:111]
ds_read_b64_tr_b16 v[24:25], v6 offset:4096
ds_read_b64_tr_b16 v[26:27], v6 offset:4608
ds_read_b128 v[40:43], v7 offset:4096
v_mfma_f32_32x32x16_bf16 v[96:111], v[60:63], v[76:79], v[96:111]
ds_read_b64_tr_b16 v[28:29], v6 offset:6144
ds_read_b64_tr_b16 v[30:31], v6 offset:6656
ds_read_b128 v[44:47], v7 offset:6144
s_waitcnt lgkmcnt(0)
v_add_u32 v6, s23, v4
v_add_u32 v7, s23, v5
s_add_u32 s23, s23, 16384
s_and_b32 s23, s23, 131071
s_barrier
v_mfma_f32_32x32x16_bf16 v[96:111], v[16:19], v[32:35], v[96:111]
ds_read_b64_tr_b16 v[48:49], v6 offset:0
ds_read_b64_tr_b16 v[50:51], v6 offset:512
ds_read_b128 v[64:67], v7 offset:0
v_mfma_f32_32x32x16_bf16 v[96:111], v[20:23], v[36:39], v[96:111]
ds_read_b64_tr_b16 v[52:53], v6 offset:2048
ds_read_b64_tr_b16 v[54:55], v6 offset:2560
ds_read_b128 v[68:71], v7 offset:2048
v_mfma_f32_32x32x16_bf16 v[96:111], v[24:27], v[40:43], v[96:111]
ds_read_b64_tr_b16 v[56:57], v6 offset:4096
ds_read_b64_tr_b16 v[58:59], v6 offset:4608
ds_read_b128 v[72:75], v7 offset:4096
v_mfma_f32_32x32x16_bf16 v[96:111], v[28:31], v[44:47], v[96:111]
ds_read_b64_tr_b16 v[60:61], v6 offset:6144
ds_read_b64_tr_b16 v[62:63], v6 offset:6656
ds_read_b128 v[76:79], v7 offset:6144
s_waitcnt lgkmcnt(0)
s_add_u32 s16, s16, 1
s_cmp_lt_u32 s16, 3
s_cbranch_scc1 ca_267
v_mfma_f32_32x32x16_bf16 v[96:111], v[48:51], v[64:67], v[96:111]
v_mfma_f32_32x32x16_bf16 v[96:111], v[52:55], v[68:71], v[96:111]
v_mfma_f32_32x32x16_bf16 v[96:111], v[56:59], v[72:75], v[96:111]
v_mfma_f32_32x32x16_bf16 v[96:111], v[60:63], v[76:79], v[96:111]
s_waitcnt vmcnt(0)
s_nop 7
v_lshlrev_b32 v9, 16, v9
v_sub_f32 v11, 1.0, v8
v_mul_f32 v12, v11, v9
v_fma_f32 v80, v11, v80, v12
v_fma_f32 v81, v11, v81, v12
v_fma_f32 v82, v11, v82, v12
v_fma_f32 v83, v11, v83, v12
v_fma_f32 v84, v11, v84, v12
v_fma_f32 v85, v11, v85, v12
v_fma_f32 v86, v11, v86, v12
v_fma_f32 v87, v11, v87, v12
v_fma_f32 v88, v11, v88, v12
v_fma_f32 v89, v11, v89, v12
v_fma_f32 v90, v11, v90, v12
v_fma_f32 v91, v11, v91, v12
v_fma_f32 v92, v11, v92, v12
v_fma_f32 v93, v11, v93, v12
v_fma_f32 v94, v11, v94, v12
v_fma_f32 v95, v11, v95, v12
v_fma_f32 v80, v8, v96, v80
v_fma_f32 v81, v8, v97, v81
v_fma_f32 v82, v8, v98, v82
v_fma_f32 v83, v8, v99, v83
v_fma_f32 v84, v8, v100, v84
v_fma_f32 v85, v8, v101, v85
v_fma_f32 v86, v8, v102, v86
v_fma_f32 v87, v8, v103, v87
v_fma_f32 v88, v8, v104, v88
v_fma_f32 v89, v8, v105, v89
v_fma_f32 v90, v8, v106, v90
v_fma_f32 v91, v8, v107, v91
v_fma_f32 v92, v8, v108, v92
v_fma_f32 v93, v8, v109, v93
v_fma_f32 v94, v8, v110, v94
v_fma_f32 v95, v8, v111, v95
v_cvt_pk_bf16_f32 v112, v80, v81
v_cvt_pk_bf16_f32 v113, v82, v83
v_cvt_pk_bf16_f32 v114, v84, v85
v_cvt_pk_bf16_f32 v115, v86, v87
v_cvt_pk_bf16_f32 v116, v88, v89
v_cvt_pk_bf16_f32 v117, v90, v91
v_cvt_pk_bf16_f32 v118, v92, v93
v_cvt_pk_bf16_f32 v119, v94, v95
s_nop 1
v_permlane32_swap_b32 v112, v114
v_permlane32_swap_b32 v113, v115
v_permlane32_swap_b32 v116, v118
v_permlane32_swap_b32 v117, v119
s_nop 1
buffer_store_dwordx4 v[112:115], v10, s[48:51], 0 offen offset:0
buffer_store_dwordx4 v[116:119], v10, s[48:51], 0 offen offset:32
gated_mix__linear_kernel_hedgehog__mixer_token_mlp__prompt_kernel_end:
s_endpgm
.section .rodata,"a"
.p2align 6
.amdhsa_kernel gated_mix__linear_kernel_hedgehog__mixer_token_mlp__prompt_kernel
  .amdhsa_next_free_vgpr 240
  .amdhsa_next_free_sgpr 102
  .amdhsa_accum_offset 240
  .amdhsa_group_segment_fixed_size 0
  .amdhsa_kernarg_size 104
  .amdhsa_user_sgpr_count 2
  .amdhsa_user_sgpr_kernarg_segment_ptr 1
  .amdhsa_system_sgpr_workgroup_id_x 1
  .amdhsa_float_denorm_mode_32 3
.end_amdhsa_kernel
.text
```
